```python
import torch

def _softmax(x, axis=-1):
    return torch.softmax(x, dim=axis)
def _gelu(x):
    return torch.nn.functional.gelu(x, approximate="tanh")
def _silu(x):
    return torch.nn.functional.silu(x)
def _sigmoid(x):
    return torch.sigmoid(x)
def _layernorm(x, axis=-1, eps=1e-5):
    m = x.mean(dim=axis, keepdim=True)
    v = x.var(dim=axis, keepdim=True, unbiased=False)
    return (x - m) / torch.sqrt(v + eps)
def _scatter_add(tgt, idx, src, axis=0):
    return tgt.clone().index_add_(axis, idx, src)
def _segment_sum(src, seg, n):
    out = torch.zeros((n,) + src.shape[1:], dtype=src.dtype)
    return out.index_add_(0, seg, src)
def _pad(x, pw):
    flat = tuple(v for pair in reversed(pw) for v in pair)
    return torch.nn.functional.pad(x, flat)

kernel_name = 'recurrent_scan__sliding_block_cached__dense_activation_relu__decode'

def setup_inputs():

    _w = (lambda a: (lambda t: t.to(torch.bfloat16) if t.is_floating_point() else t)(torch.as_tensor(a)))
    def _A_setup():
        B, Sq, D = 2, 1, 1024
        Hq, Hkv, Sk, Dh = 32, 4, 32768, 128
        assert Hq % Hkv == 0, (Hq, Hkv)
        return {
            "x": _w((lambda *s: torch.randn(*s, dtype=torch.bfloat16) * 0.05)(B, Sq, D)),
            "k_cache": _w((lambda *s: torch.randn(*s, dtype=torch.bfloat16) * 1.6)(B, Hkv, Sk, Dh)),
            "v_cache": _w((lambda *s: torch.randn(*s, dtype=torch.bfloat16) * 0.2)(B, Hkv, Sk, Dh)),
            "wq": _w((lambda *s: torch.randn(*s, dtype=torch.bfloat16) * 1.6)(D, Hq * Dh) * (D ** -0.5)),
            "wo": _w((lambda *s: torch.randn(*s, dtype=torch.bfloat16) * 0.2)(Hq * Dh, D) * ((Hq * Dh) ** -0.5)),
        }
    _A_in = _A_setup()

    def _B_setup():
        B, S, D, Dff = 2, 1, 1024, 3584
        return {
            "x": _w((lambda *s: torch.randn(*s, dtype=torch.bfloat16) * 0.05)(B, S, D)),
            "w1": _w((lambda *s: torch.randn(*s, dtype=torch.bfloat16) * 0.1)(D, Dff)),
            "w2": _w((lambda *s: torch.randn(*s, dtype=torch.bfloat16) * 0.1)(Dff, D)),
        }
    _B_in = _B_setup()

    return {
        "A_x": _A_in["x"],
        "A_k_cache": _A_in["k_cache"],
        "A_v_cache": _A_in["v_cache"],
        "A_wq": _A_in["wq"],
        "A_wo": _A_in["wo"],
        "B_x": _B_in["x"],
        "B_w1": _B_in["w1"],
        "B_w2": _B_in["w2"],
    }

def reference(A_x, A_k_cache, A_v_cache, A_wq, A_wo, B_x, B_w1, B_w2):
    def _A_ref(x, k_cache, v_cache, wq, wo):
        B, Sq, D = x.shape
        Hq, Dh = 32, 128
        Hkv, Sk = k_cache.shape[1], k_cache.shape[2]
        W = min(4096, max(256, Sk // 4))
        rep = Hq // Hkv
        q = (lambda x, *d: x.permute(*d))((x @ wq).reshape(B, Sq, Hq, Dh), 0, 2, 1, 3)
        k = (lambda x, n, axis: torch.repeat_interleave(x, n, dim=axis))(k_cache[:, :, Sk - W:, :], rep, axis=1)
        v = (lambda x, n, axis: torch.repeat_interleave(x, n, dim=axis))(v_cache[:, :, Sk - W:, :], rep, axis=1)
        scores = torch.einsum("bhqd,bhkd->bhqk", q, k) * (Dh ** -0.5)
        p = _softmax(scores, axis=-1)
        o = torch.einsum("bhqk,bhkd->bhqd", p, v)
        return (lambda x, *d: x.permute(*d))(o, 0, 2, 1, 3).reshape(B, Sq, Hq * Dh) @ wo

    def _B_ref(x, w1, w2):
        h = torch.einsum("bsd,df->bsf", x, w1)
        zero = torch.zeros_like(h)
        h = torch.maximum(h, zero)
        return torch.einsum("bsf,fd->bsd", h, w2)

    x = A_x
    xn = _layernorm(x, axis=-1)
    s = _A_ref(xn, A_k_cache, A_v_cache, A_wq, A_wo)
    g = _silu(_B_ref(xn, B_w1, B_w2))
    return x + s * g
```

```asm
; @launch grid=(256,1,1) block=(576,1,1) lds=140416
.amdgcn_target "amdgcn-amd-amdhsa--gfx950"
.text
.globl recurrent_scan__sliding_block_cached__dense_activation_relu__decode_kernel
.p2align 8
.type recurrent_scan__sliding_block_cached__dense_activation_relu__decode_kernel,@function
recurrent_scan__sliding_block_cached__dense_activation_relu__decode_kernel:
    s_cmp_ge_u32 s2, 256
    s_cbranch_scc1 L_end
    s_load_dwordx16 s[4:19], s[0:1], 0
    s_load_dwordx2 s[20:21], s[0:1], 64
    s_load_dwordx2 s[22:23], s[0:1], 80
    v_and_b32 v1, 63, v0
    v_lshrrev_b32 v12, 6, v0
    v_and_b32 v2, 15, v1
    v_lshrrev_b32 v3, 4, v1
    v_readfirstlane_b32 s3, v12
    s_and_b32 s60, s2, 7
    s_bfe_u32 s61, s2, 0x40003
    v_mov_b32 v44, 140096
    v_mov_b32 v14, 0
    v_lshl_add_u32 v15, v2, 2, v44
    ds_write_b32 v15, v14
    s_sub_u32 s3, s3, 1
    s_mov_b32 s27, 0x20000
    s_mov_b32 s50, 268435456
    s_mov_b32 s51, 0x20000
    v_lshlrev_b32 v12, 1, v3
    v_xor_b32 v4, v2, v12
    s_cmp_ge_u32 s2, 128
    s_cbranch_scc1 L_teamA
    v_and_b32 v12, 7, v4
    v_lshlrev_b32 v12, 4, v12
    v_lshrrev_b32 v13, 3, v4
    v_lshl_add_u32 v5, v13, 8, v12
    v_lshl_add_u32 v28, v3, 13, v5
    v_xor_b32 v29, 0x100, v28
    s_lshr_b32 s59, s60, 1
    s_lshl_b32 s63, s59, 21
    s_and_b32 s64, s60, 1
    s_lshl_b32 s64, s64, 12
    s_add_u32 s63, s63, s64
    s_lshr_b32 s64, s61, 1
    s_lshl_b32 s64, s64, 9
    s_add_u32 s63, s63, s64
    s_and_b32 s64, s61, 1
    s_lshl_b32 s64, s64, 7
    s_add_u32 s63, s63, s64
    s_mov_b32 s97, s59
    s_mov_b32 s26, 8388608
    s_mov_b32 s54, 4096
    s_mov_b32 s55, 0x20000
    v_lshlrev_b32 v13, 5, v1
    s_lshl_b32 s64, s3, 11
    s_mov_b32 m0, 0
    s_cmp_lt_i32 s3, 0
    s_waitcnt lgkmcnt(0)
    s_barrier
    s_mov_b32 s24, s10
    s_mov_b32 s25, s11
    s_mov_b32 s52, s4
    s_mov_b32 s53, s5
    s_mov_b32 s48, s22
    s_mov_b32 s49, s23
    s_cbranch_scc1 L_loaderF
    s_load_dword s62, s[22:23], 0
    s_cmp_ge_u32 s3, 2
    s_cbranch_scc1 L_nox
    buffer_load_dwordx4 v[16:19], v13, s[52:55], s64 offen
    buffer_load_dwordx4 v[20:23], v13, s[52:55], s64 offen offset:16
L_nox:
    s_lshr_b32 s63, s3, 1
    s_cmp_lg_u32 s63, 1
    s_cbranch_scc1 L_computeF
    s_getpc_b64 s[64:65]
L_pc16:
    s_and_b32 s63, s3, 1
    s_lshl_b32 s63, s63, 13
    v_lshlrev_b32 v15, 7, v1
    v_add_u32 v15, s63, v15
    v_min_u32 v15, (L_end - L_pc16), v15
    global_load_dword v47, v15, s[64:65]
    s_branch L_computeF
L_loaderF:
    s_mov_b32 s66, 15
L_ld17:
    buffer_load_dwordx4 v28, s[24:27], s63 offen offset:0 nt lds
    s_add_u32 s63, s63, 31744
    buffer_load_dwordx4 v28, s[24:27], s63 offen offset:1024 nt lds
    s_add_u32 s63, s63, 31744
    buffer_load_dwordx4 v29, s[24:27], s63 offen offset:2048 nt lds
    s_add_u32 s63, s63, 31744
    buffer_load_dwordx4 v29, s[24:27], s63 offen offset:3072 nt lds
    s_add_u32 s63, s63, 35840
    s_add_u32 m0, m0, 4096
    s_sub_u32 s66, s66, 1
    s_cmp_lg_u32 s66, 0
    s_cbranch_scc1 L_ld17
    v_lshl_add_u32 v47, v1, 2, v44
    v_add_u32 v47, 64, v47
    s_mov_b32 s64, 140096
    v_writelane_b32 v47, s64, 0
    s_mov_b32 s28, s16
    s_mov_b32 s29, s17
    s_mov_b32 s30, 7340032
    s_mov_b32 s31, 0x20000
    s_mov_b32 s32, s18
    s_mov_b32 s33, s19
    s_mov_b32 s34, 7340032
    s_mov_b32 s35, 0x20000
    s_mov_b32 s66, 1
    v_mov_b32 v30, 1
L_ld18:
    s_waitcnt vmcnt(56)
    ds_max_u32 v47, v30
    buffer_load_dwordx4 v28, s[24:27], s63 offen offset:0 nt lds
    s_add_u32 s63, s63, 31744
    buffer_load_dwordx4 v28, s[24:27], s63 offen offset:1024 nt lds
    s_add_u32 s63, s63, 31744
    buffer_load_dwordx4 v29, s[24:27], s63 offen offset:2048 nt lds
    s_add_u32 s63, s63, 31744
    buffer_load_dwordx4 v29, s[24:27], s63 offen offset:3072 nt lds
    s_add_u32 s63, s63, 35840
    v_add_u32 v30, 1, v30
    s_add_u32 m0, m0, 4096
    s_sub_u32 s66, s66, 1
    s_cmp_lg_u32 s66, 0
    s_cbranch_scc1 L_ld18
    s_cmp_lt_u32 s61, 14
    s_cbranch_scc1 L_f_heavy
    s_waitcnt vmcnt(0)
    v_mov_b32 v30, 48
    ds_max_u32 v47, v30
    s_branch L_fin
L_f_heavy:
    s_and_b32 s64, s61, 3
    s_cmp_eq_u32 s64, 1
    s_cbranch_scc1 L_f_slow
    s_movk_i32 s64, 7168
    v_mul_lo_u32 v24, v3, s64
    v_add_u32 v24, v24, v5
    v_xor_b32 v25, 0x100, v5
    v_sub_u32 v25, v25, v5
    v_add_u32 v25, v25, v24
    s_mul_i32 s63, s97, 1835008
    s_and_b32 s64, s60, 1
    s_mul_i32 s64, s64, 7
    s_lshr_b32 s65, s61, 1
    s_add_u32 s64, s64, s65
    s_lshl_b32 s64, s64, 9
    s_add_u32 s63, s63, s64
    s_andn2_b32 s64, 1, s61
    s_lshl_b32 s64, s64, 7
    s_add_u32 s63, s63, s64
    s_waitcnt vmcnt(48)
    v_mov_b32 v30, 4
    ds_max_u32 v47, v30
    s_waitcnt vmcnt(32)
    v_mov_b32 v30, 8
    ds_max_u32 v47, v30
    s_waitcnt vmcnt(16)
    v_mov_b32 v30, 12
    ds_max_u32 v47, v30
    s_mov_b32 s66, 5
    v_mov_b32 v30, 15
L_ld19:
    s_waitcnt vmcnt(4)
    ds_max_u32 v47, v30
    buffer_load_dwordx4 v24, s[28:31], s63 offen offset:0 nt lds
    s_add_u32 s63, s63, 27648
    buffer_load_dwordx4 v24, s[28:31], s63 offen offset:1024 nt lds
    s_add_u32 s63, s63, 27648
    buffer_load_dwordx4 v25, s[28:31], s63 offen offset:2048 nt lds
    s_add_u32 s63, s63, 27648
    buffer_load_dwordx4 v25, s[28:31], s63 offen offset:3072 nt lds
    s_add_u32 s63, s63, 31744
    v_add_u32 v30, 1, v30
    s_add_u32 m0, m0, 4096
    s_sub_u32 s66, s66, 1
    s_cmp_lg_u32 s66, 0
    s_cbranch_scc1 L_ld19
    s_mov_b32 s66, 11
    v_mov_b32 v30, 12
L_ld20:
    s_waitcnt vmcnt(36)
    ds_max_u32 v47, v30
    buffer_load_dwordx4 v24, s[28:31], s63 offen offset:0 nt lds
    s_add_u32 s63, s63, 27648
    buffer_load_dwordx4 v24, s[28:31], s63 offen offset:1024 nt lds
    s_add_u32 s63, s63, 27648
    buffer_load_dwordx4 v25, s[28:31], s63 offen offset:2048 nt lds
    s_add_u32 s63, s63, 27648
    buffer_load_dwordx4 v25, s[28:31], s63 offen offset:3072 nt lds
    s_add_u32 s63, s63, 31744
    v_add_u32 v30, 1, v30
    s_add_u32 m0, m0, 4096
    s_sub_u32 s66, s66, 1
    s_cmp_lg_u32 s66, 0
    s_cbranch_scc1 L_ld20
    v_lshlrev_b32 v26, 4, v4
    v_lshl_add_u32 v26, v3, 11, v26
    v_xor_b32 v27, 0x80, v26
    s_lshl_b32 s63, s61, 19
    s_lshl_b32 s64, s60, 8
    s_add_u32 s63, s63, s64
    s_mov_b32 s98, 0
L_lw21:
    ds_read_b32 v46, v44 offset:8
    s_add_u32 s98, s98, 1
    s_cmp_gt_u32 s98, 16777216
    s_cbranch_scc1 L_lw21_x
    s_waitcnt lgkmcnt(0)
    v_cmp_gt_u32 vcc, 8, v46
    s_cbranch_vccnz L_lw21
L_lw21_x:
    s_mov_b32 m0, 0
    s_mov_b32 s66, 16
    v_mov_b32 v30, 23
L_ld22:
    s_waitcnt vmcnt(36)
    ds_max_u32 v47, v30
    buffer_load_dwordx4 v26, s[32:35], s63 offen offset:0 nt lds
    s_add_u32 s63, s63, 7168
    buffer_load_dwordx4 v26, s[32:35], s63 offen offset:1024 nt lds
    s_add_u32 s63, s63, 7168
    buffer_load_dwordx4 v27, s[32:35], s63 offen offset:2048 nt lds
    s_add_u32 s63, s63, 7168
    buffer_load_dwordx4 v27, s[32:35], s63 offen offset:3072 nt lds
    s_add_u32 s63, s63, 11264
    v_add_u32 v30, 1, v30
    s_add_u32 m0, m0, 4096
    s_sub_u32 s66, s66, 1
    s_cmp_lg_u32 s66, 0
    s_cbranch_scc1 L_ld22
    s_waitcnt vmcnt(32)
    v_mov_b32 v30, 40
    ds_max_u32 v47, v30
    s_waitcnt vmcnt(24)
    v_mov_b32 v30, 42
    ds_max_u32 v47, v30
    s_waitcnt vmcnt(16)
    v_mov_b32 v30, 44
    ds_max_u32 v47, v30
    s_waitcnt vmcnt(8)
    v_mov_b32 v30, 46
    ds_max_u32 v47, v30
    s_waitcnt vmcnt(0)
    v_mov_b32 v30, 48
    ds_max_u32 v47, v30
    s_branch L_fin
L_f_slow:
    s_movk_i32 s64, 7168
    v_mul_lo_u32 v24, v3, s64
    v_add_u32 v24, v24, v5
    v_xor_b32 v25, 0x100, v5
    v_sub_u32 v25, v25, v5
    v_add_u32 v25, v25, v24
    s_mul_i32 s63, s97, 1835008
    s_and_b32 s64, s60, 1
    s_mul_i32 s64, s64, 7
    s_lshr_b32 s65, s61, 1
    s_add_u32 s64, s64, s65
    s_lshl_b32 s64, s64, 9
    s_add_u32 s63, s63, s64
    s_andn2_b32 s64, 1, s61
    s_lshl_b32 s64, s64, 7
    s_add_u32 s63, s63, s64
    s_waitcnt vmcnt(48)
    v_mov_b32 v30, 4
    ds_max_u32 v47, v30
    s_waitcnt vmcnt(32)
    v_mov_b32 v30, 8
    ds_max_u32 v47, v30
    s_waitcnt vmcnt(16)
    v_mov_b32 v30, 12
    ds_max_u32 v47, v30
    s_mov_b32 s66, 4
    v_mov_b32 v30, 15
L_ld23:
    s_waitcnt vmcnt(4)
    ds_max_u32 v47, v30
    buffer_load_dwordx4 v24, s[28:31], s63 offen offset:0 nt lds
    s_add_u32 s63, s63, 27648
    buffer_load_dwordx4 v24, s[28:31], s63 offen offset:1024 nt lds
    s_add_u32 s63, s63, 27648
    buffer_load_dwordx4 v25, s[28:31], s63 offen offset:2048 nt lds
    s_add_u32 s63, s63, 27648
    buffer_load_dwordx4 v25, s[28:31], s63 offen offset:3072 nt lds
    s_add_u32 s63, s63, 31744
    v_add_u32 v30, 1, v30
    s_add_u32 m0, m0, 4096
    s_sub_u32 s66, s66, 1
    s_cmp_lg_u32 s66, 0
    s_cbranch_scc1 L_ld23
    s_mov_b32 s66, 12
    v_mov_b32 v30, 9
L_ld24:
    s_waitcnt vmcnt(44)
    ds_max_u32 v47, v30
    buffer_load_dwordx4 v24, s[28:31], s63 offen offset:0 nt lds
    s_add_u32 s63, s63, 27648
    buffer_load_dwordx4 v24, s[28:31], s63 offen offset:1024 nt lds
    s_add_u32 s63, s63, 27648
    buffer_load_dwordx4 v25, s[28:31], s63 offen offset:2048 nt lds
    s_add_u32 s63, s63, 27648
    buffer_load_dwordx4 v25, s[28:31], s63 offen offset:3072 nt lds
    s_add_u32 s63, s63, 31744
    v_add_u32 v30, 1, v30
    s_add_u32 m0, m0, 4096
    s_sub_u32 s66, s66, 1
    s_cmp_lg_u32 s66, 0
    s_cbranch_scc1 L_ld24
    v_lshlrev_b32 v26, 4, v4
    v_lshl_add_u32 v26, v3, 11, v26
    v_xor_b32 v27, 0x80, v26
    s_lshl_b32 s63, s61, 19
    s_lshl_b32 s64, s60, 8
    s_add_u32 s63, s63, s64
    s_mov_b32 s98, 0
L_lw25:
    ds_read_b32 v46, v44 offset:8
    s_add_u32 s98, s98, 1
    s_cmp_gt_u32 s98, 16777216
    s_cbranch_scc1 L_lw25_x
    s_waitcnt lgkmcnt(0)
    v_cmp_gt_u32 vcc, 8, v46
    s_cbranch_vccnz L_lw25
L_lw25_x:
    s_mov_b32 m0, 0
    s_mov_b32 s66, 16
    v_mov_b32 v30, 21
L_ld26:
    s_waitcnt vmcnt(44)
    ds_max_u32 v47, v30
    buffer_load_dwordx4 v26, s[32:35], s63 offen offset:0 nt lds
    s_add_u32 s63, s63, 7168
    buffer_load_dwordx4 v26, s[32:35], s63 offen offset:1024 nt lds
    s_add_u32 s63, s63, 7168
    buffer_load_dwordx4 v27, s[32:35], s63 offen offset:2048 nt lds
    s_add_u32 s63, s63, 7168
    buffer_load_dwordx4 v27, s[32:35], s63 offen offset:3072 nt lds
    s_add_u32 s63, s63, 11264
    v_add_u32 v30, 1, v30
    s_add_u32 m0, m0, 4096
    s_sub_u32 s66, s66, 1
    s_cmp_lg_u32 s66, 0
    s_cbranch_scc1 L_ld26
    s_waitcnt vmcnt(40)
    v_mov_b32 v30, 38
    ds_max_u32 v47, v30
    s_waitcnt vmcnt(32)
    v_mov_b32 v30, 40
    ds_max_u32 v47, v30
    s_waitcnt vmcnt(24)
    v_mov_b32 v30, 42
    ds_max_u32 v47, v30
    s_waitcnt vmcnt(16)
    v_mov_b32 v30, 44
    ds_max_u32 v47, v30
    s_waitcnt vmcnt(8)
    v_mov_b32 v30, 46
    ds_max_u32 v47, v30
    s_waitcnt vmcnt(0)
    v_mov_b32 v30, 48
    ds_max_u32 v47, v30
    s_branch L_fin
L_teamA:
    v_xor_b32 v18, v2, v3
    v_lshlrev_b32 v18, 4, v18
    v_lshl_add_u32 v18, v3, 8, v18
    v_xor_b32 v19, 0x40, v18
    v_xor_b32 v20, 0x80, v18
    v_xor_b32 v21, 0xc0, v18
    s_lshl_b32 s63, s60, 23
    s_lshl_b32 s64, s61, 16
    s_add_u32 s63, s63, s64
    s_add_u32 s63, s63, 7340032
    s_mov_b32 s68, s63
    s_mov_b32 s26, 67108864
    s_mov_b32 m0, 0
    s_cmp_lt_i32 s3, 0
    s_waitcnt lgkmcnt(0)
    s_barrier
    s_mov_b32 s24, s6
    s_mov_b32 s25, s7
    s_mov_b32 s48, s22
    s_mov_b32 s49, s23
    s_cbranch_scc1 L_loaderA
    s_load_dword s62, s[22:23], 0
    s_lshr_b32 s63, s3, 1
    s_cmp_lg_u32 s63, 1
    s_cbranch_scc1 L_computeA
    s_getpc_b64 s[64:65]
L_pc1:
    s_and_b32 s63, s3, 1
    s_lshl_b32 s63, s63, 13
    v_lshlrev_b32 v15, 7, v1
    v_add_u32 v15, s63, v15
    v_min_u32 v15, (L_end - L_pc1), v15
    global_load_dword v47, v15, s[64:65]
    s_branch L_computeA
L_loaderA:
    s_mov_b32 s66, 8
L_ld2:
    buffer_load_dwordx4 v18, s[24:27], s63 offen offset:0 nt lds
    buffer_load_dwordx4 v19, s[24:27], s63 offen offset:1024 nt lds
    buffer_load_dwordx4 v20, s[24:27], s63 offen offset:2048 nt lds
    buffer_load_dwordx4 v21, s[24:27], s63 offen offset:3072 nt lds
    s_add_u32 s63, s63, 4096
    s_add_u32 m0, m0, 4096
    s_sub_u32 s66, s66, 1
    s_cmp_lg_u32 s66, 0
    s_cbranch_scc1 L_ld2
    v_lshl_add_u32 v47, v1, 2, v44
    v_add_u32 v47, 64, v47
    s_mov_b32 s64, 140096
    v_writelane_b32 v47, s64, 0
    s_mov_b32 s28, s8
    s_mov_b32 s29, s9
    s_mov_b32 s30, 67108864
    s_mov_b32 s31, 0x20000
    s_mov_b32 s32, s12
    s_mov_b32 s33, s13
    s_mov_b32 s34, 8388608
    s_mov_b32 s35, 0x20000
    s_mov_b32 s66, 2
    v_mov_b32 v30, 1
L_ld3:
    s_waitcnt vmcnt(28)
    ds_max_u32 v47, v30
    buffer_load_dwordx4 v18, s[24:27], s63 offen offset:0 nt lds
    buffer_load_dwordx4 v19, s[24:27], s63 offen offset:1024 nt lds
    buffer_load_dwordx4 v20, s[24:27], s63 offen offset:2048 nt lds
    buffer_load_dwordx4 v21, s[24:27], s63 offen offset:3072 nt lds
    s_add_u32 s63, s63, 4096
    v_add_u32 v30, 1, v30
    s_add_u32 m0, m0, 4096
    s_sub_u32 s66, s66, 1
    s_cmp_lg_u32 s66, 0
    s_cbranch_scc1 L_ld3
    s_mov_b32 s66, 4
L_ld4:
    buffer_load_dwordx4 v18, s[24:27], s63 offen offset:0 nt lds
    buffer_load_dwordx4 v19, s[24:27], s63 offen offset:1024 nt lds
    buffer_load_dwordx4 v20, s[24:27], s63 offen offset:2048 nt lds
    buffer_load_dwordx4 v21, s[24:27], s63 offen offset:3072 nt lds
    s_add_u32 s63, s63, 4096
    s_add_u32 m0, m0, 4096
    s_sub_u32 s66, s66, 1
    s_cmp_lg_u32 s66, 0
    s_cbranch_scc1 L_ld4
    s_mov_b32 s66, 2
    v_mov_b32 v30, 1
L_ld5:
    s_waitcnt vmcnt(52)
    ds_max_u32 v47, v30
    buffer_load_dwordx4 v18, s[24:27], s63 offen offset:0 nt lds
    buffer_load_dwordx4 v19, s[24:27], s63 offen offset:1024 nt lds
    buffer_load_dwordx4 v20, s[24:27], s63 offen offset:2048 nt lds
    buffer_load_dwordx4 v21, s[24:27], s63 offen offset:3072 nt lds
    s_add_u32 s63, s63, 4096
    v_add_u32 v30, 1, v30
    s_add_u32 m0, m0, 4096
    s_sub_u32 s66, s66, 1
    s_cmp_lg_u32 s66, 0
    s_cbranch_scc1 L_ld5
    s_mov_b32 s63, s68
    v_lshlrev_b32 v22, 4, v4
    v_lshl_add_u32 v22, v3, 8, v22
    v_xor_b32 v23, 0x80, v22
    s_mov_b32 s66, 16
    v_mov_b32 v30, 3
L_ld6:
    s_waitcnt vmcnt(52)
    ds_max_u32 v47, v30
    buffer_load_dwordx4 v22, s[28:31], s63 offen offset:0 nt lds
    buffer_load_dwordx4 v22, s[28:31], s63 offen offset:1024 nt lds
    buffer_load_dwordx4 v23, s[28:31], s63 offen offset:2048 nt lds
    buffer_load_dwordx4 v23, s[28:31], s63 offen offset:3072 nt lds
    s_add_u32 s63, s63, 4096
    v_add_u32 v30, 1, v30
    s_add_u32 m0, m0, 4096
    s_sub_u32 s66, s66, 1
    s_cmp_lg_u32 s66, 0
    s_cbranch_scc1 L_ld6
    v_lshlrev_b32 v32, 4, v4
    v_lshl_add_u32 v32, v3, 11, v32
    v_xor_b32 v33, 0x80, v32
    s_lshl_b32 s63, s61, 19
    s_lshl_b32 s64, s60, 8
    s_add_u32 s63, s63, s64
    s_mov_b32 s98, 0
L_lw7:
    ds_read_b32 v46, v44 offset:8
    s_add_u32 s98, s98, 1
    s_cmp_gt_u32 s98, 16777216
    s_cbranch_scc1 L_lw7_x
    s_waitcnt lgkmcnt(0)
    v_cmp_gt_u32 vcc, 8, v46
    s_cbranch_vccnz L_lw7
L_lw7_x:
    s_mov_b32 m0, 0
    s_waitcnt vmcnt(48)
    v_mov_b32 v30, 20
    ds_max_u32 v47, v30
    s_waitcnt vmcnt(40)
    v_mov_b32 v30, 22
    ds_max_u32 v47, v30
    s_waitcnt vmcnt(32)
    v_mov_b32 v30, 24
    ds_max_u32 v47, v30
    s_waitcnt vmcnt(24)
    v_mov_b32 v30, 26
    ds_max_u32 v47, v30
    s_waitcnt vmcnt(16)
    v_mov_b32 v30, 28
    ds_max_u32 v47, v30
    s_waitcnt vmcnt(8)
    v_mov_b32 v30, 30
    ds_max_u32 v47, v30
    s_waitcnt vmcnt(0)
    v_mov_b32 v30, 32
    ds_max_u32 v47, v30
    s_waitcnt lgkmcnt(0)
    s_barrier
    s_mov_b32 s66, 6
L_ld8:
    buffer_load_dwordx4 v32, s[32:35], s63 offen offset:0 nt lds
    s_add_u32 s63, s63, 7168
    buffer_load_dwordx4 v32, s[32:35], s63 offen offset:1024 nt lds
    s_add_u32 s63, s63, 7168
    buffer_load_dwordx4 v33, s[32:35], s63 offen offset:2048 nt lds
    s_add_u32 s63, s63, 7168
    buffer_load_dwordx4 v33, s[32:35], s63 offen offset:3072 nt lds
    s_add_u32 s63, s63, 11264
    s_add_u32 m0, m0, 4096
    s_sub_u32 s66, s66, 1
    s_cmp_lg_u32 s66, 0
    s_cbranch_scc1 L_ld8
    s_barrier
    s_barrier
    s_mov_b32 s66, 10
    v_mov_b32 v30, 27
L_ld9:
    s_waitcnt vmcnt(44)
    ds_max_u32 v47, v30
    buffer_load_dwordx4 v32, s[32:35], s63 offen offset:0 nt lds
    s_add_u32 s63, s63, 7168
    buffer_load_dwordx4 v32, s[32:35], s63 offen offset:1024 nt lds
    s_add_u32 s63, s63, 7168
    buffer_load_dwordx4 v33, s[32:35], s63 offen offset:2048 nt lds
    s_add_u32 s63, s63, 7168
    buffer_load_dwordx4 v33, s[32:35], s63 offen offset:3072 nt lds
    s_add_u32 s63, s63, 11264
    v_add_u32 v30, 1, v30
    s_add_u32 m0, m0, 4096
    s_sub_u32 s66, s66, 1
    s_cmp_lg_u32 s66, 0
    s_cbranch_scc1 L_ld9
    s_waitcnt vmcnt(40)
    v_mov_b32 v30, 38
    ds_max_u32 v47, v30
    s_waitcnt vmcnt(32)
    v_mov_b32 v30, 40
    ds_max_u32 v47, v30
    s_waitcnt vmcnt(24)
    v_mov_b32 v30, 42
    ds_max_u32 v47, v30
    s_waitcnt vmcnt(16)
    v_mov_b32 v30, 44
    ds_max_u32 v47, v30
    s_waitcnt vmcnt(8)
    v_mov_b32 v30, 46
    ds_max_u32 v47, v30
    s_waitcnt vmcnt(0)
    v_mov_b32 v30, 48
    ds_max_u32 v47, v30
    s_branch L_fin
L_computeA:
    v_mov_b32 v45, 1
    v_mov_b32 v43, 512
    s_movk_i32 s67, 1023
    s_and_b32 s13, s3, 1
    v_lshrrev_b32 v12, 2, v2
    v_and_b32 v13, 1, v3
    v_lshl_or_b32 v14, v13, 2, v12
    v_lshlrev_b32 v40, 1, v14
    v_bfe_u32 v41, v2, 1, 1
    s_lshl_b32 s63, s3, 1
    v_add_u32 v7, s63, v41
    v_xor_b32 v7, v7, v40
    v_lshlrev_b32 v7, 4, v7
    v_lshl_add_u32 v8, v3, 3, v12
    v_lshl_add_u32 v7, v8, 8, v7
    v_and_b32 v42, 1, v2
    v_lshl_add_u32 v7, v42, 3, v7
    v_add_u32 v8, 0x10000, v7
    v_and_b32 v12, 31, v1
    v_lshlrev_b32 v20, 3, v12
    v_lshlrev_b32 v13, 4, v12
    v_lshrrev_b32 v14, 5, v1
    v_lshl_add_u32 v13, v14, 10, v13
    s_mov_b32 s56, s20
    s_mov_b32 s57, s21
    s_mov_b32 s58, 4096
    s_mov_b32 s59, 0x20000
    s_mov_b32 s52, s4
    s_mov_b32 s53, s5
    s_mov_b32 s54, 4096
    s_mov_b32 s55, 0x20000
    s_lshl_b32 s17, s61, 1
    s_add_u32 s17, s17, s13
    s_lshl_b32 s63, s17, 5
    s_lshl_b32 s33, s60, 15
    s_add_u32 s33, s33, s63
    s_add_u32 s34, s33, 1626112
    s_add_u32 s33, s33, 1363968
    s_lshl_b32 s35, s60, 8
    s_lshl_b32 s63, s17, 3
    s_add_u32 s35, s35, s63
    s_mov_b32 s38, 0xbfb8aa3b
    s_mov_b32 s46, 0x3fffffff
    s_mov_b32 s47, 0x3fffffff
    s_mov_b32 s6, 0x00030003
    s_mov_b32 s7, 0x00030003
    v_and_b32 v12, 31, v1
    v_lshrrev_b32 v14, 5, v1
    v_lshlrev_b32 v14, 4, v14
    v_min_u32 v12, 29, v12
    v_lshl_add_u32 v36, v12, 10, v14
    v_lshlrev_b32 v38, 7, v14
    s_lshr_b32 s10, s60, 2
    s_and_b32 s11, s60, 3
    s_lshl_b32 s25, s10, 16
    s_lshl_b32 s63, s11, 14
    s_add_u32 s25, s25, s63
    s_lshl_b32 s63, s3, 11
    s_add_u32 s25, s25, s63
    s_add_u32 s25, s25, 4096
    s_lshl_b32 s26, s11, 8
    s_lshl_b32 s63, s10, 4
    s_add_u32 s26, s26, s63
    s_add_u32 s26, s26, s61
    s_lshl_b32 s27, s26, 4
    s_add_u32 s27, s27, 774144
    s_lshl_b32 s26, s26, 9
    s_lshl_b32 s63, s3, 6
    s_add_u32 s26, s26, s63
    s_add_u32 s26, s26, 249856
    s_add_u32 s41, s26, 540672
    s_add_u32 s42, s27, 540672
    s_lshl_b32 s43, s17, 10
    s_add_u32 s43, s43, 1331200
    s_lshl_b32 s31, s60, 5
    s_add_u32 s31, s31, s61
    s_lshl_b32 s31, s31, 10
    s_lshl_b32 s63, s3, 7
    s_add_u32 s31, s31, s63
    s_add_u32 s32, s31, 1626112
    s_add_u32 s31, s31, 1363968
    s_mov_b32 s36, 0x3db504f3
    s_mov_b32 s37, 0x3fb8aa3b
    s_mov_b32 s8, 0x00ff00ff
    s_mov_b32 s9, 0x00ff00ff
    v_lshlrev_b32 v12, 4, v3
    v_lshl_add_u32 v5, v2, 14, v12
    v_lshlrev_b32 v6, 9, v2
    v_and_b32 v14, 7, v2
    v_mul_u32_u24 v9, 288, v14
    v_add3_u32 v9, v9, v12, v44
    v_subrev_u32 v9, 9024, v9
    v_mul_u32_u24 v15, 544, v14
    v_add_u32 v15, 133376, v15
    v_add_u32 v10, v15, v12
    v_lshl_add_u32 v23, v3, 3, v15
    s_lshl_b32 s63, s3, 6
    v_add_u32 v23, s63, v23
    v_lshrrev_b32 v15, 3, v2
    v_lshl_add_u32 v23, v15, 5, v23
    v_lshlrev_b32 v34, 7, v14
    v_lshl_add_u32 v34, v3, 5, v34
    v_add_u32 v34, 137984, v34
    s_lshl_b32 s63, s3, 2
    v_add_u32 v35, s63, v34
    s_mov_b32 s14, 0xff00ff00
    s_mov_b32 s15, 0xff00ff00
    v_lshlrev_b32 v21, 5, v14
    v_add_u32 v21, 137728, v21
    s_lshl_b32 s63, s3, 2
    v_add_u32 v22, s63, v21
    s_mul_i32 s63, s3, 288
    s_add_u32 s63, s63, 131072
    v_add_u32 v24, s63, v20
    v_xor_b32 v16, v2, v3
    v_lshlrev_b32 v16, 4, v16
    v_lshl_add_u32 v16, v2, 8, v16
    s_lshl_b32 s63, s3, 13
    v_add_u32 v16, s63, v16
    v_xor_b32 v17, 0x40, v16
    v_xor_b32 v18, 0x80, v16
    v_xor_b32 v19, 0xc0, v16
    v_mul_u32_u24 v26, 544, v42
    v_lshl_add_u32 v26, v3, 4, v26
    v_add_u32 v26, 139008, v26
    v_lshlrev_b32 v29, 4, v2
    v_lshl_add_u32 v29, v3, 5, v29
    v_lshrrev_b32 v12, 5, v1
    v_mul_u32_u24 v33, 544, v12
    s_lshl_b32 s63, s13, 8
    s_add_u32 s63, s63, 139008
    v_add3_u32 v33, v33, v20, s63
    v_lshlrev_b32 v39, 4, v1
    s_mov_b32 s16, 0x07060302
    s_waitcnt lgkmcnt(0)
    s_add_u32 s69, s62, 1
    v_mov_b32 v11, s69
    s_lshr_b32 s62, s69, 10
    v_add_u32 v25, s62, v11
    s_lshr_b32 s62, s69, 20
    v_add_u32 v27, s62, v11
    s_lshr_b32 s62, s69, 30
    v_add_u32 v28, s62, v11
    s_mov_b32 s96, 0
    s_mov_b32 s44, 0
    s_mov_b64 exec, 0
L_dryA:
    s_mov_b32 s98, 0
L_lw10:
    ds_read_b32 v46, v44 offset:0
    s_add_u32 s98, s98, 1
    s_cmp_gt_u32 s98, 16777216
    s_cbranch_scc1 L_lw10_x
    s_waitcnt lgkmcnt(0)
    v_cmp_gt_u32 vcc, 16, v46
    s_cbranch_vccnz L_lw10
L_lw10_x:
    ds_read_b128 v[136:139], v16 offset:0
    ds_read_b128 v[140:143], v17 offset:0
    ds_read_b128 v[144:147], v18 offset:0
    ds_read_b128 v[148:151], v19 offset:0
    ds_read_b128 v[152:155], v16 offset:4096
    ds_read_b128 v[156:159], v17 offset:4096
    ds_read_b128 v[160:163], v18 offset:4096
    ds_read_b128 v[164:167], v19 offset:4096
    s_waitcnt lgkmcnt(0)
    s_mul_i32 exec_lo, s44, 1
    s_mov_b32 exec_hi, 0
    ds_add_u32 v44, v45 offset:8
    s_mov_b32 exec_lo, s96
    s_mov_b32 exec_hi, s96
    s_mov_b32 s98, 0
L_lw11:
    ds_read_b32 v46, v44 offset:0
    s_add_u32 s98, s98, 1
    s_cmp_gt_u32 s98, 16777216
    s_cbranch_scc1 L_lw11_x
    s_waitcnt lgkmcnt(0)
    v_cmp_gt_u32 vcc, 28, v46
    s_cbranch_vccnz L_lw11
L_lw11_x:
    s_cbranch_execz L_dz1
    buffer_load_dwordx4 v[116:119], v13, s[48:51], s25 offen offset:0 sc1
    buffer_load_dwordx4 v[120:123], v13, s[48:51], s25 offen offset:512 sc1
L_dz1:
    s_mov_b32 s98, 0
L_lw12:
    ds_read_b32 v46, v44 offset:0
    s_add_u32 s98, s98, 1
    s_cmp_gt_u32 s98, 16777216
    s_cbranch_scc1 L_lw12_x
    s_waitcnt lgkmcnt(0)
    v_cmp_gt_u32 vcc, 32, v46
    s_cbranch_vccnz L_lw12
L_lw12_x:
    ds_read_b64_tr_b16 v[48:49], v8 offset:0
    ds_read_b64_tr_b16 v[50:51], v8 offset:1024
    ds_read_b64_tr_b16 v[52:53], v8 offset:8192
    ds_read_b64_tr_b16 v[54:55], v8 offset:9216
    ds_read_b64_tr_b16 v[56:57], v8 offset:16384
    ds_read_b64_tr_b16 v[58:59], v8 offset:17408
    ds_read_b64_tr_b16 v[60:61], v8 offset:24576
    ds_read_b64_tr_b16 v[62:63], v8 offset:25600
    ds_read_b64_tr_b16 v[64:65], v8 offset:32768
    ds_read_b64_tr_b16 v[66:67], v8 offset:33792
    ds_read_b64_tr_b16 v[68:69], v8 offset:40960
    ds_read_b64_tr_b16 v[70:71], v8 offset:41984
    ds_read_b64_tr_b16 v[72:73], v8 offset:49152
    ds_read_b64_tr_b16 v[74:75], v8 offset:50176
    ds_read_b64_tr_b16 v[76:77], v8 offset:57344
    ds_read_b64_tr_b16 v[78:79], v8 offset:58368
    s_mov_b32 s64, 0
L_pq:
    s_waitcnt vmcnt(0)
    v_xor_b32 v14, v116, v11
    v_xor_b32 v15, v117, v25
    v_bitop3_b32 v14, v118, v27, v14 bitop3:0xbe
    v_bitop3_b32 v15, v119, v28, v15 bitop3:0xbe
    v_bitop3_b32 v14, v120, v11, v14 bitop3:0xbe
    v_bitop3_b32 v15, v121, v25, v15 bitop3:0xbe
    v_bitop3_b32 v14, v122, v27, v14 bitop3:0xbe
    v_bitop3_b32 v15, v123, v28, v15 bitop3:0xbe
    v_bitop3_b32 v12, v14, v15, s67 bitop3:0xa8
    v_cmp_ne_u32 vcc, 0, v12
    s_cbranch_vccz L_pq_ok
    s_add_u32 s64, s64, 1
    s_cmp_gt_u32 s64, 1048576
    s_cbranch_scc1 L_pq_ok
    s_mov_b64 exec, vcc
    s_cbranch_execz L_dz2
    buffer_load_dwordx4 v[116:119], v13, s[48:51], s25 offen offset:0 sc1
    buffer_load_dwordx4 v[120:123], v13, s[48:51], s25 offen offset:512 sc1
L_dz2:
    s_mov_b32 exec_lo, s96
    s_mov_b32 exec_hi, s96
    s_branch L_pq
L_pq_ok:
    v_bfi_b32 v116, s67, v43, v116
    v_bfi_b32 v117, s67, v43, v117
    v_bfi_b32 v118, s67, v43, v118
    v_bfi_b32 v119, s67, v43, v119
    v_bfi_b32 v120, s67, v43, v120
    v_bfi_b32 v121, s67, v43, v121
    v_bfi_b32 v122, s67, v43, v122
    v_bfi_b32 v123, s67, v43, v123
    v_pk_add_f32 v[116:117], v[116:117], v[120:121]
    v_pk_add_f32 v[118:119], v[118:119], v[122:123]
    v_mov_b32 v120, v116
    v_mov_b32 v121, v117
    v_mov_b32 v122, v118
    v_mov_b32 v123, v119
    s_nop 1
    v_permlane32_swap_b32 v116, v120
    v_permlane32_swap_b32 v117, v121
    v_permlane32_swap_b32 v118, v122
    v_permlane32_swap_b32 v119, v123
    s_nop 1
    v_pk_add_f32 v[116:117], v[116:117], v[120:121]
    v_pk_add_f32 v[118:119], v[118:119], v[122:123]
    v_cvt_pk_bf16_f32 v120, v116, v117
    v_cvt_pk_bf16_f32 v121, v118, v119
    ds_write_b64 v24, v[120:121]
    s_waitcnt lgkmcnt(0)
    s_cbranch_execz L_dz3
    s_barrier
L_dz3:
    ds_read_b128 v[80:83], v9 offset:0
    ds_read_b128 v[84:87], v9 offset:64
    ds_read_b128 v[88:91], v9 offset:128
    ds_read_b128 v[92:95], v9 offset:192
    s_waitcnt lgkmcnt(3)
    v_mfma_f32_16x16x32_bf16 v[112:115], v[136:139], v[80:83], 0
    v_mfma_f32_16x16x32_bf16 v[96:99], v[152:155], v[80:83], 0
    s_waitcnt lgkmcnt(2)
    v_mfma_f32_16x16x32_bf16 v[112:115], v[140:143], v[84:87], v[112:115]
    v_mfma_f32_16x16x32_bf16 v[96:99], v[156:159], v[84:87], v[96:99]
    s_waitcnt lgkmcnt(1)
    v_mfma_f32_16x16x32_bf16 v[112:115], v[144:147], v[88:91], v[112:115]
    v_mfma_f32_16x16x32_bf16 v[96:99], v[160:163], v[88:91], v[96:99]
    s_waitcnt lgkmcnt(0)
    v_mfma_f32_16x16x32_bf16 v[112:115], v[148:151], v[92:95], v[112:115]
    v_mfma_f32_16x16x32_bf16 v[96:99], v[164:167], v[92:95], v[96:99]
    s_nop 7
    v_cndmask_b32 v120, v112, v96, s[14:15]
    v_cndmask_b32 v121, v113, v97, s[14:15]
    v_cndmask_b32 v122, v114, v98, s[14:15]
    v_cndmask_b32 v123, v115, v99, s[14:15]
    v_cvt_pk_bf16_f32 v116, v120, v121
    v_cvt_pk_bf16_f32 v117, v122, v123
    v_lshlrev_b32 v120, 16, v116
    v_and_b32 v121, 0xffff0000, v116
    v_lshlrev_b32 v122, 16, v117
    v_and_b32 v123, 0xffff0000, v117
    v_mul_f32 v120, s36, v120
    v_mul_f32 v121, s36, v121
    v_mul_f32 v122, s36, v122
    v_mul_f32 v123, s36, v123
    v_cvt_pk_bf16_f32 v116, v120, v121
    v_cvt_pk_bf16_f32 v117, v122, v123
    v_lshlrev_b32 v120, 16, v116
    v_and_b32 v121, 0xffff0000, v116
    v_lshlrev_b32 v122, 16, v117
    v_and_b32 v123, 0xffff0000, v117
    v_max3_f32 v124, v120, v121, v122
    v_max_f32 v124, v124, v123
    s_nop 1
    v_max_f32_dpp v124, v124, v124 row_ror:8 row_mask:0xf bank_mask:0xf
    v_mov_b32 v125, v124
    s_nop 1
    v_permlane16_swap_b32 v124, v125
    s_nop 1
    v_max_f32 v124, v124, v125
    v_mov_b32 v125, v124
    s_nop 1
    v_permlane32_swap_b32 v124, v125
    s_nop 1
    v_max_f32 v124, v124, v125
    v_sub_f32 v120, v120, v124
    v_sub_f32 v121, v121, v124
    v_sub_f32 v122, v122, v124
    v_sub_f32 v123, v123, v124
    v_mul_f32 v120, s37, v120
    v_mul_f32 v121, s37, v121
    v_mul_f32 v122, s37, v122
    v_mul_f32 v123, s37, v123
    v_exp_f32 v120, v120
    v_exp_f32 v121, v121
    v_exp_f32 v122, v122
    v_exp_f32 v123, v123
    s_mul_i32 exec_lo, s44, 0xff
    s_mov_b32 exec_hi, 0
    ds_write_b32 v22, v124
    s_mov_b32 exec_lo, s96
    s_mov_b32 exec_hi, s96
    v_cvt_pk_bf16_f32 v116, v120, v121
    v_cvt_pk_bf16_f32 v117, v122, v123
    v_pk_add_f32 v[120:121], v[120:121], v[122:123]
    ds_write_b64 v23, v[116:117]
    v_add_f32 v120, v120, v121
    s_nop 1
    v_add_f32_dpp v120, v120, v120 row_ror:8 row_mask:0xf bank_mask:0xf
    s_mul_i32 exec_lo, s8, s44
    s_mul_i32 exec_hi, s9, s44
    ds_write_b32 v35, v120
    s_mov_b32 exec_lo, s96
    s_mov_b32 exec_hi, s96
    s_waitcnt lgkmcnt(0)
    s_cbranch_execz L_dz4
    s_barrier
L_dz4:
    ds_read_b128 v[128:131], v21
    ds_read_b128 v[132:135], v21 offset:16
    ds_read_b128 v[80:83], v10 offset:0
    ds_read_b128 v[84:87], v10 offset:64
    ds_read_b128 v[88:91], v10 offset:128
    ds_read_b128 v[92:95], v10 offset:192
    ds_read_b128 v[96:99], v10 offset:256
    ds_read_b128 v[100:103], v10 offset:320
    ds_read_b128 v[104:107], v10 offset:384
    ds_read_b128 v[108:111], v10 offset:448
    s_waitcnt lgkmcnt(8)
    v_max3_f32 v124, v128, v129, v130
    v_max3_f32 v125, v131, v132, v133
    v_max3_f32 v124, v124, v134, v135
    v_max_f32 v124, v124, v125
    s_waitcnt lgkmcnt(7)
    v_mfma_f32_16x16x32_bf16 v[136:139], v[48:51], v[80:83], 0
    v_sub_f32 v128, v128, v124
    v_mul_f32 v128, s37, v128
    v_exp_f32 v128, v128
    s_waitcnt lgkmcnt(6)
    v_mfma_f32_16x16x32_bf16 v[140:143], v[52:55], v[84:87], 0
    v_sub_f32 v129, v129, v124
    v_mul_f32 v129, s37, v129
    v_exp_f32 v129, v129
    s_waitcnt lgkmcnt(5)
    v_mfma_f32_16x16x32_bf16 v[144:147], v[56:59], v[88:91], 0
    v_sub_f32 v130, v130, v124
    v_mul_f32 v130, s37, v130
    v_exp_f32 v130, v130
    s_waitcnt lgkmcnt(4)
    v_mfma_f32_16x16x32_bf16 v[148:151], v[60:63], v[92:95], 0
    v_sub_f32 v131, v131, v124
    v_mul_f32 v131, s37, v131
    v_exp_f32 v131, v131
    s_waitcnt lgkmcnt(3)
    v_mfma_f32_16x16x32_bf16 v[152:155], v[64:67], v[96:99], 0
    v_sub_f32 v132, v132, v124
    v_mul_f32 v132, s37, v132
    v_exp_f32 v132, v132
    s_waitcnt lgkmcnt(2)
    v_mfma_f32_16x16x32_bf16 v[156:159], v[68:71], v[100:103], 0
    v_sub_f32 v133, v133, v124
    v_mul_f32 v133, s37, v133
    v_exp_f32 v133, v133
    s_waitcnt lgkmcnt(1)
    v_mfma_f32_16x16x32_bf16 v[160:163], v[72:75], v[104:107], 0
    v_sub_f32 v134, v134, v124
    v_mul_f32 v134, s37, v134
    v_exp_f32 v134, v134
    s_waitcnt lgkmcnt(0)
    v_mfma_f32_16x16x32_bf16 v[164:167], v[76:79], v[108:111], 0
    v_sub_f32 v135, v135, v124
    v_mul_f32 v135, s37, v135
    v_exp_f32 v135, v135
    s_cmp_lg_u32 s3, 7
    s_cbranch_scc1 L_noL
    ds_read_b128 v[80:83], v34
    ds_read_b128 v[84:87], v34 offset:16
L_noL:
    v_pk_mul_f32 v[112:113], v[136:137], v[128:129] op_sel:[0,0] op_sel_hi:[1,0]
    v_pk_mul_f32 v[114:115], v[138:139], v[128:129] op_sel:[0,0] op_sel_hi:[1,0]
    v_pk_fma_f32 v[112:113], v[140:141], v[128:129], v[112:113] op_sel:[0,1,0] op_sel_hi:[1,1,1]
    v_pk_fma_f32 v[114:115], v[142:143], v[128:129], v[114:115] op_sel:[0,1,0] op_sel_hi:[1,1,1]
    v_pk_fma_f32 v[112:113], v[144:145], v[130:131], v[112:113] op_sel:[0,0,0] op_sel_hi:[1,0,1]
    v_pk_fma_f32 v[114:115], v[146:147], v[130:131], v[114:115] op_sel:[0,0,0] op_sel_hi:[1,0,1]
    v_pk_fma_f32 v[112:113], v[148:149], v[130:131], v[112:113] op_sel:[0,1,0] op_sel_hi:[1,1,1]
    v_pk_fma_f32 v[114:115], v[150:151], v[130:131], v[114:115] op_sel:[0,1,0] op_sel_hi:[1,1,1]
    v_pk_fma_f32 v[112:113], v[152:153], v[132:133], v[112:113] op_sel:[0,0,0] op_sel_hi:[1,0,1]
    v_pk_fma_f32 v[114:115], v[154:155], v[132:133], v[114:115] op_sel:[0,0,0] op_sel_hi:[1,0,1]
    v_pk_fma_f32 v[112:113], v[156:157], v[132:133], v[112:113] op_sel:[0,1,0] op_sel_hi:[1,1,1]
    v_pk_fma_f32 v[114:115], v[158:159], v[132:133], v[114:115] op_sel:[0,1,0] op_sel_hi:[1,1,1]
    v_pk_fma_f32 v[112:113], v[160:161], v[134:135], v[112:113] op_sel:[0,0,0] op_sel_hi:[1,0,1]
    v_pk_fma_f32 v[114:115], v[162:163], v[134:135], v[114:115] op_sel:[0,0,0] op_sel_hi:[1,0,1]
    v_pk_fma_f32 v[112:113], v[164:165], v[134:135], v[112:113] op_sel:[0,1,0] op_sel_hi:[1,1,1]
    v_pk_fma_f32 v[114:115], v[166:167], v[134:135], v[114:115] op_sel:[0,1,0] op_sel_hi:[1,1,1]
    v_bfi_b32 v112, s67, v11, v112
    v_bfi_b32 v113, s67, v25, v113
    v_bfi_b32 v114, s67, v27, v114
    v_bfi_b32 v115, s67, v28, v115
    s_mul_i32 exec_lo, s8, s44
    s_mul_i32 exec_hi, s9, s44
    s_cbranch_execz L_dz5
    buffer_store_dwordx4 v[112:115], v5, s[48:51], s26 offen
L_dz5:
    s_mov_b32 exec_lo, s96
    s_mov_b32 exec_hi, s96
    s_cbranch_scc1 L_noML
    s_waitcnt lgkmcnt(0)
    v_pk_mul_f32 v[80:81], v[80:81], v[128:129]
    v_pk_mul_f32 v[82:83], v[82:83], v[130:131]
    v_pk_mul_f32 v[84:85], v[84:85], v[132:133]
    v_pk_mul_f32 v[86:87], v[86:87], v[134:135]
    v_pk_add_f32 v[80:81], v[80:81], v[82:83]
    v_pk_add_f32 v[84:85], v[84:85], v[86:87]
    v_pk_add_f32 v[80:81], v[80:81], v[84:85]
    v_add_f32 v117, v80, v81
    v_mov_b32 v118, v117
    s_nop 1
    v_permlane16_swap_b32 v117, v118
    s_nop 1
    v_add_f32 v117, v117, v118
    v_mov_b32 v118, v117
    s_nop 1
    v_permlane32_swap_b32 v117, v118
    s_nop 1
    v_add_f32 v117, v117, v118
    v_mov_b32 v116, v124
    v_bfi_b32 v116, s67, v11, v116
    v_bfi_b32 v117, s67, v25, v117
    v_bfi_b32 v118, s67, v27, v118
    v_bfi_b32 v119, s67, v28, v119
    s_mul_i32 exec_lo, s44, 0xff
    s_mov_b32 exec_hi, 0
    s_cbranch_execz L_dz6
    buffer_store_dwordx4 v[116:119], v6, s[48:51], s27 offen
    buffer_store_dwordx4 v[116:119], v6, s[48:51], s42 offen sc1
L_dz6:
    s_mov_b32 exec_lo, s96
    s_mov_b32 exec_hi, s96
L_noML:
    s_cbranch_execz L_dz7
    s_barrier
L_dz7:
    s_mul_i32 exec_lo, s8, s44
    s_mul_i32 exec_hi, s9, s44
    s_cbranch_execz L_dz8
    buffer_store_dwordx4 v[112:115], v5, s[48:51], s41 offen sc1
L_dz8:
    s_mov_b32 exec_lo, s96
    s_mov_b32 exec_hi, s96
    s_cbranch_execz L_dz9
    buffer_load_dwordx2 v[136:137], v38, s[52:55], s35 offen
L_dz9:
    s_mov_b32 s98, 0
L_lw13:
    ds_read_b32 v46, v44 offset:0
    s_add_u32 s98, s98, 1
    s_cmp_gt_u32 s98, 16777216
    s_cbranch_scc1 L_lw13_x
    s_waitcnt lgkmcnt(0)
    v_cmp_gt_u32 vcc, 40, v46
    s_cbranch_vccnz L_lw13
L_lw13_x:
    ds_read_b64_tr_b16 v[48:49], v7 offset:0
    ds_read_b64_tr_b16 v[50:51], v7 offset:1024
    ds_read_b64_tr_b16 v[52:53], v7 offset:8192
    ds_read_b64_tr_b16 v[54:55], v7 offset:9216
    ds_read_b64_tr_b16 v[56:57], v7 offset:16384
    ds_read_b64_tr_b16 v[58:59], v7 offset:17408
    ds_read_b64_tr_b16 v[60:61], v7 offset:24576
    ds_read_b64_tr_b16 v[62:63], v7 offset:25600
    s_lshr_b32 s18, s3, 1
    s_cmp_lg_u32 s18, 1
    s_cbranch_scc1 L_st2_done
    s_mov_b32 s98, 0
L_lw14:
    ds_read_b32 v46, v44 offset:0
    s_add_u32 s98, s98, 1
    s_cmp_gt_u32 s98, 16777216
    s_cbranch_scc1 L_lw14_x
    s_waitcnt lgkmcnt(0)
    v_cmp_gt_u32 vcc, 44, v46
    s_cbranch_vccnz L_lw14
L_lw14_x:
    s_cbranch_execz L_dz10
    buffer_load_dwordx4 v[116:119], v39, s[48:51], s43 offen sc1
L_dz10:
    s_mov_b32 s64, 0
L_po2:
    s_waitcnt vmcnt(0)
    v_xor_b32 v14, v116, v11
    v_xor_b32 v15, v117, v25
    v_bitop3_b32 v14, v118, v27, v14 bitop3:0xbe
    v_bitop3_b32 v15, v119, v28, v15 bitop3:0xbe
    v_bitop3_b32 v12, v14, v15, s67 bitop3:0xa8
    v_cmp_ne_u32 vcc, 0, v12
    s_cbranch_vccz L_po2_ok
    s_add_u32 s64, s64, 1
    s_cmp_gt_u32 s64, 1048576
    s_cbranch_scc1 L_po2_ok
    s_mov_b64 exec, vcc
    s_cbranch_execz L_dz11
    buffer_load_dwordx4 v[116:119], v39, s[48:51], s43 offen sc1
L_dz11:
    s_mov_b32 exec_lo, s96
    s_mov_b32 exec_hi, s96
    s_branch L_po2
L_po2_ok:
    v_perm_b32 v120, v117, v116, s16
    v_perm_b32 v121, v119, v118, s16
    ds_write_b64 v33, v[120:121]
L_st2_done:
    s_waitcnt vmcnt(0)
    s_mov_b32 s98, 0
L_lw15:
    ds_read_b32 v46, v44 offset:0
    s_add_u32 s98, s98, 1
    s_cmp_gt_u32 s98, 16777216
    s_cbranch_scc1 L_lw15_x
    s_waitcnt lgkmcnt(0)
    v_cmp_gt_u32 vcc, 48, v46
    s_cbranch_vccnz L_lw15
L_lw15_x:
    ds_read_b64_tr_b16 v[64:65], v7 offset:32768
    ds_read_b64_tr_b16 v[66:67], v7 offset:33792
    ds_read_b64_tr_b16 v[68:69], v7 offset:40960
    ds_read_b64_tr_b16 v[70:71], v7 offset:41984
    ds_read_b64_tr_b16 v[72:73], v7 offset:49152
    ds_read_b64_tr_b16 v[74:75], v7 offset:50176
    ds_read_b64_tr_b16 v[76:77], v7 offset:57344
    ds_read_b64_tr_b16 v[78:79], v7 offset:58368
    s_waitcnt lgkmcnt(0)
    s_cbranch_execz L_dz12
    s_barrier
L_dz12:
    ds_read_b128 v[80:83], v26 offset:0
    ds_read_b128 v[84:87], v26 offset:64
    ds_read_b128 v[88:91], v26 offset:128
    ds_read_b128 v[92:95], v26 offset:192
    ds_read_b128 v[96:99], v26 offset:256
    ds_read_b128 v[100:103], v26 offset:320
    ds_read_b128 v[104:107], v26 offset:384
    ds_read_b128 v[108:111], v26 offset:448
    s_waitcnt lgkmcnt(7)
    v_mfma_f32_16x16x32_bf16 v[112:115], v[48:51], v[80:83], 0
    s_waitcnt lgkmcnt(6)
    v_mfma_f32_16x16x32_bf16 v[112:115], v[52:55], v[84:87], v[112:115]
    s_waitcnt lgkmcnt(5)
    v_mfma_f32_16x16x32_bf16 v[112:115], v[56:59], v[88:91], v[112:115]
    s_waitcnt lgkmcnt(4)
    v_mfma_f32_16x16x32_bf16 v[112:115], v[60:63], v[92:95], v[112:115]
    s_waitcnt lgkmcnt(3)
    v_mfma_f32_16x16x32_bf16 v[112:115], v[64:67], v[96:99], v[112:115]
    s_waitcnt lgkmcnt(2)
    v_mfma_f32_16x16x32_bf16 v[112:115], v[68:71], v[100:103], v[112:115]
    s_waitcnt lgkmcnt(1)
    v_mfma_f32_16x16x32_bf16 v[112:115], v[72:75], v[104:107], v[112:115]
    s_waitcnt lgkmcnt(0)
    v_mfma_f32_16x16x32_bf16 v[112:115], v[76:79], v[108:111], v[112:115]
    s_nop 7
    v_bfi_b32 v112, s67, v11, v112
    v_bfi_b32 v113, s67, v25, v113
    v_bfi_b32 v114, s67, v27, v114
    v_bfi_b32 v115, s67, v28, v115
    s_mul_i32 exec_lo, s6, s44
    s_mul_i32 exec_hi, s7, s44
    s_cbranch_execz L_dz13
    buffer_store_dwordx4 v[112:115], v29, s[48:51], s31 offen
    buffer_store_dwordx4 v[112:115], v29, s[48:51], s32 offen sc1
L_dz13:
    s_mov_b32 exec_lo, s96
    s_mov_b32 exec_hi, s96
    s_lshr_b32 s18, s3, 1
    s_cmp_lg_u32 s18, 2
    s_cbranch_scc1 L_dryendA
    v_lshlrev_b32 v128, 16, v136
    v_and_b32 v129, 0xffff0000, v136
    v_lshlrev_b32 v130, 16, v137
    v_and_b32 v131, 0xffff0000, v137
    s_mov_b32 s19, s33
    s_cbranch_execz L_dz14
    buffer_load_dwordx4 v[116:119], v36, s[48:51], s19 offen sc1
L_dz14:
    s_mov_b32 s64, 0
L_pf:
    s_waitcnt vmcnt(0)
    v_xor_b32 v14, v116, v11
    v_xor_b32 v15, v117, v25
    v_bitop3_b32 v14, v118, v27, v14 bitop3:0xbe
    v_bitop3_b32 v15, v119, v28, v15 bitop3:0xbe
    v_bitop3_b32 v12, v14, v15, s67 bitop3:0xa8
    v_cmp_ne_u32 vcc, 0, v12
    s_cbranch_vccz L_pf_ok
    s_add_u32 s64, s64, 1
    s_cmp_gt_u32 s64, 1048576
    s_cbranch_scc1 L_pf_ok
    s_mov_b64 exec, vcc
    s_and_b32 s63, s64, 1
    s_cmp_gt_u32 s64, 48
    s_cselect_b32 s63, s63, 0
    s_cmp_lg_u32 s63, 0
    s_cselect_b32 s19, s34, s33
    s_cbranch_execz L_dz15
    buffer_load_dwordx4 v[116:119], v36, s[48:51], s19 offen sc1
L_dz15:
    s_mov_b32 exec_lo, s96
    s_mov_b32 exec_hi, s96
    s_branch L_pf
L_pf_ok:
    v_bfi_b32 v116, s67, v43, v116
    v_bfi_b32 v117, s67, v43, v117
    v_bfi_b32 v118, s67, v43, v118
    v_bfi_b32 v119, s67, v43, v119
    v_cndmask_b32 v116, 0, v116, s[46:47]
    v_cndmask_b32 v117, 0, v117, s[46:47]
    v_cndmask_b32 v118, 0, v118, s[46:47]
    v_cndmask_b32 v119, 0, v119, s[46:47]
    v_add_f32_dpp v116, v116, v116 quad_perm:[1,0,3,2] row_mask:0xf bank_mask:0xf
    v_add_f32_dpp v117, v117, v117 quad_perm:[1,0,3,2] row_mask:0xf bank_mask:0xf
    v_add_f32_dpp v118, v118, v118 quad_perm:[1,0,3,2] row_mask:0xf bank_mask:0xf
    v_add_f32_dpp v119, v119, v119 quad_perm:[1,0,3,2] row_mask:0xf bank_mask:0xf
    v_add_f32_dpp v116, v116, v116 quad_perm:[2,3,0,1] row_mask:0xf bank_mask:0xf
    v_add_f32_dpp v117, v117, v117 quad_perm:[2,3,0,1] row_mask:0xf bank_mask:0xf
    v_add_f32_dpp v118, v118, v118 quad_perm:[2,3,0,1] row_mask:0xf bank_mask:0xf
    v_add_f32_dpp v119, v119, v119 quad_perm:[2,3,0,1] row_mask:0xf bank_mask:0xf
    v_add_f32_dpp v116, v116, v116 row_half_mirror row_mask:0xf bank_mask:0xf
    v_add_f32_dpp v117, v117, v117 row_half_mirror row_mask:0xf bank_mask:0xf
    v_add_f32_dpp v118, v118, v118 row_half_mirror row_mask:0xf bank_mask:0xf
    v_add_f32_dpp v119, v119, v119 row_half_mirror row_mask:0xf bank_mask:0xf
    v_add_f32_dpp v116, v116, v116 row_mirror row_mask:0xf bank_mask:0xf
    v_add_f32_dpp v117, v117, v117 row_mirror row_mask:0xf bank_mask:0xf
    v_add_f32_dpp v118, v118, v118 row_mirror row_mask:0xf bank_mask:0xf
    v_add_f32_dpp v119, v119, v119 row_mirror row_mask:0xf bank_mask:0xf
    v_cvt_pk_bf16_f32 v124, v116, v117
    v_cvt_pk_bf16_f32 v125, v118, v119
    v_lshlrev_b32 v116, 16, v124
    v_and_b32 v117, 0xffff0000, v124
    v_lshlrev_b32 v118, 16, v125
    v_and_b32 v119, 0xffff0000, v125
    v_mul_f32 v124, s38, v116
    v_mul_f32 v125, s38, v117
    v_mul_f32 v126, s38, v118
    v_mul_f32 v127, s38, v119
    v_exp_f32 v124, v124
    v_exp_f32 v125, v125
    v_exp_f32 v126, v126
    v_exp_f32 v127, v127
    s_nop 0
    v_add_f32 v124, 1.0, v124
    v_add_f32 v125, 1.0, v125
    v_add_f32 v126, 1.0, v126
    v_add_f32 v127, 1.0, v127
    v_rcp_f32 v124, v124
    v_rcp_f32 v125, v125
    v_rcp_f32 v126, v126
    v_rcp_f32 v127, v127
    s_nop 0
    v_mul_f32 v120, v116, v124
    v_mul_f32 v121, v117, v125
    v_mul_f32 v122, v118, v126
    v_mul_f32 v123, v119, v127
    v_cvt_pk_bf16_f32 v124, v120, v121
    v_cvt_pk_bf16_f32 v125, v122, v123
    v_lshlrev_b32 v120, 16, v124
    v_and_b32 v121, 0xffff0000, v124
    v_lshlrev_b32 v122, 16, v125
    v_and_b32 v123, 0xffff0000, v125
    s_nop 0
    v_mul_f32_dpp v120, v116, v120 row_bcast:15 row_mask:0xa bank_mask:0xf
    v_mul_f32_dpp v121, v117, v121 row_bcast:15 row_mask:0xa bank_mask:0xf
    v_mul_f32_dpp v122, v118, v122 row_bcast:15 row_mask:0xa bank_mask:0xf
    v_mul_f32_dpp v123, v119, v123 row_bcast:15 row_mask:0xa bank_mask:0xf
    v_cvt_pk_bf16_f32 v124, v120, v121
    v_cvt_pk_bf16_f32 v125, v122, v123
    v_lshlrev_b32 v120, 16, v124
    v_and_b32 v121, 0xffff0000, v124
    v_lshlrev_b32 v122, 16, v125
    v_and_b32 v123, 0xffff0000, v125
    v_add_f32 v120, v120, v128
    v_add_f32 v121, v121, v129
    v_add_f32 v122, v122, v130
    v_add_f32 v123, v123, v131
    v_cvt_pk_bf16_f32 v124, v120, v121
    v_cvt_pk_bf16_f32 v125, v122, v123
    s_mov_b32 s64, 0x80000000
    s_mul_i32 exec_lo, s64, s44
    s_mul_i32 exec_hi, s64, s44
    s_cbranch_execz L_dz16
    buffer_store_dwordx2 v[124:125], v38, s[56:59], s35 offen
L_dz16:
    s_cmp_lg_u32 s35, 0
    s_cbranch_scc1 L_dryendA
    s_mul_i32 exec_lo, s44, 1
    s_mov_b32 exec_hi, 0
    v_mov_b32 v12, 0
    v_mov_b32 v14, s69
    s_cbranch_execz L_dz17
    buffer_store_dword v14, v12, s[48:51], 0 offen sc1
L_dz17:
L_dryendA:
    s_cmp_lg_u32 s96, 0
    s_cbranch_scc1 L_fin
    s_mov_b32 s96, -1
    s_mov_b32 s44, 1
    s_mov_b64 exec, -1
    s_branch L_dryA
    s_branch L_fin
L_computeF:
    v_mov_b32 v45, 1
    s_cmp_ge_u32 s3, 2
    s_cbranch_scc1 L_ln_done
    s_waitcnt vmcnt(0)
    v_lshlrev_b32 v48, 16, v16
    v_and_b32 v49, 0xffff0000, v16
    v_lshlrev_b32 v50, 16, v17
    v_and_b32 v51, 0xffff0000, v17
    v_lshlrev_b32 v52, 16, v18
    v_and_b32 v53, 0xffff0000, v18
    v_lshlrev_b32 v54, 16, v19
    v_and_b32 v55, 0xffff0000, v19
    v_lshlrev_b32 v56, 16, v20
    v_and_b32 v57, 0xffff0000, v20
    v_lshlrev_b32 v58, 16, v21
    v_and_b32 v59, 0xffff0000, v21
    v_lshlrev_b32 v60, 16, v22
    v_and_b32 v61, 0xffff0000, v22
    v_lshlrev_b32 v62, 16, v23
    v_and_b32 v63, 0xffff0000, v23
    v_pk_add_f32 v[72:73], v[48:49], v[50:51]
    v_pk_add_f32 v[74:75], v[52:53], v[54:55]
    v_pk_add_f32 v[76:77], v[56:57], v[58:59]
    v_pk_add_f32 v[78:79], v[60:61], v[62:63]
    v_pk_add_f32 v[72:73], v[72:73], v[74:75]
    v_pk_add_f32 v[76:77], v[76:77], v[78:79]
    v_pk_add_f32 v[72:73], v[72:73], v[76:77]
    v_add_f32 v64, v72, v73
    s_nop 1
    v_add_f32_dpp v64, v64, v64 quad_perm:[1,0,3,2] row_mask:0xf bank_mask:0xf
    s_nop 1
    v_add_f32_dpp v64, v64, v64 quad_perm:[2,3,0,1] row_mask:0xf bank_mask:0xf
    s_nop 1
    v_add_f32_dpp v64, v64, v64 row_half_mirror row_mask:0xf bank_mask:0xf
    s_nop 1
    v_add_f32_dpp v64, v64, v64 row_mirror row_mask:0xf bank_mask:0xf
    s_nop 1
    v_add_f32_dpp v64, v64, v64 row_bcast:15 row_mask:0xa bank_mask:0xf
    s_nop 1
    v_add_f32_dpp v64, v64, v64 row_bcast:31 row_mask:0xc bank_mask:0xf
    s_nop 0
    v_readlane_b32 s63, v64, 63
    s_nop 1
    v_mov_b32 v66, s63
    v_mul_f32 v66, 0xba800000, v66
    v_mov_b32 v67, v66
    v_pk_add_f32 v[72:73], v[48:49], v[66:67]
    v_pk_add_f32 v[74:75], v[50:51], v[66:67]
    v_pk_add_f32 v[76:77], v[52:53], v[66:67]
    v_pk_add_f32 v[78:79], v[54:55], v[66:67]
    v_pk_add_f32 v[80:81], v[56:57], v[66:67]
    v_pk_add_f32 v[82:83], v[58:59], v[66:67]
    v_pk_add_f32 v[84:85], v[60:61], v[66:67]
    v_pk_add_f32 v[86:87], v[62:63], v[66:67]
    v_pk_mul_f32 v[64:65], v[72:73], v[72:73]
    v_pk_mul_f32 v[68:69], v[74:75], v[74:75]
    v_pk_fma_f32 v[64:65], v[76:77], v[76:77], v[64:65]
    v_pk_fma_f32 v[68:69], v[78:79], v[78:79], v[68:69]
    v_pk_fma_f32 v[64:65], v[80:81], v[80:81], v[64:65]
    v_pk_fma_f32 v[68:69], v[82:83], v[82:83], v[68:69]
    v_pk_fma_f32 v[64:65], v[84:85], v[84:85], v[64:65]
    v_pk_fma_f32 v[68:69], v[86:87], v[86:87], v[68:69]
    v_pk_add_f32 v[64:65], v[64:65], v[68:69]
    v_add_f32 v64, v64, v65
    s_nop 1
    v_add_f32_dpp v64, v64, v64 quad_perm:[1,0,3,2] row_mask:0xf bank_mask:0xf
    s_nop 1
    v_add_f32_dpp v64, v64, v64 quad_perm:[2,3,0,1] row_mask:0xf bank_mask:0xf
    s_nop 1
    v_add_f32_dpp v64, v64, v64 row_half_mirror row_mask:0xf bank_mask:0xf
    s_nop 1
    v_add_f32_dpp v64, v64, v64 row_mirror row_mask:0xf bank_mask:0xf
    s_nop 1
    v_add_f32_dpp v64, v64, v64 row_bcast:15 row_mask:0xa bank_mask:0xf
    s_nop 1
    v_add_f32_dpp v64, v64, v64 row_bcast:31 row_mask:0xc bank_mask:0xf
    s_nop 0
    v_readlane_b32 s63, v64, 63
    s_nop 1
    v_mov_b32 v68, s63
    v_mul_f32 v68, 0x3a800000, v68
    v_cvt_pk_bf16_f32 v70, v66, v68
    v_lshlrev_b32 v66, 16, v70
    v_mov_b32 v67, v66
    v_and_b32 v68, 0xffff0000, v70
    v_add_f32 v68, 0x3727c5ac, v68
    v_cvt_pk_bf16_f32 v68, v68, v68
    v_lshlrev_b32 v68, 16, v68
    v_sqrt_f32 v68, v68
    v_pk_add_f32 v[72:73], v[48:49], v[66:67]
    v_pk_add_f32 v[74:75], v[50:51], v[66:67]
    v_pk_add_f32 v[76:77], v[52:53], v[66:67]
    v_pk_add_f32 v[78:79], v[54:55], v[66:67]
    v_pk_add_f32 v[80:81], v[56:57], v[66:67]
    v_pk_add_f32 v[82:83], v[58:59], v[66:67]
    v_pk_add_f32 v[84:85], v[60:61], v[66:67]
    v_pk_add_f32 v[86:87], v[62:63], v[66:67]
    v_cvt_pk_bf16_f32 v68, v68, v68
    v_lshlrev_b32 v68, 16, v68
    v_rcp_f32 v70, v68
    v_xor_b32 v68, 0x80000000, v68
    v_mov_b32 v69, v68
    v_mov_b32 v71, v70
    v_cvt_pk_bf16_f32 v48, v72, v73
    v_cvt_pk_bf16_f32 v49, v74, v75
    v_cvt_pk_bf16_f32 v50, v76, v77
    v_cvt_pk_bf16_f32 v51, v78, v79
    v_cvt_pk_bf16_f32 v52, v80, v81
    v_cvt_pk_bf16_f32 v53, v82, v83
    v_cvt_pk_bf16_f32 v54, v84, v85
    v_cvt_pk_bf16_f32 v55, v86, v87
    v_lshlrev_b32 v72, 16, v48
    v_and_b32 v73, 0xffff0000, v48
    v_lshlrev_b32 v74, 16, v49
    v_and_b32 v75, 0xffff0000, v49
    v_lshlrev_b32 v76, 16, v50
    v_and_b32 v77, 0xffff0000, v50
    v_lshlrev_b32 v78, 16, v51
    v_and_b32 v79, 0xffff0000, v51
    v_lshlrev_b32 v80, 16, v52
    v_and_b32 v81, 0xffff0000, v52
    v_lshlrev_b32 v82, 16, v53
    v_and_b32 v83, 0xffff0000, v53
    v_lshlrev_b32 v84, 16, v54
    v_and_b32 v85, 0xffff0000, v54
    v_lshlrev_b32 v86, 16, v55
    v_and_b32 v87, 0xffff0000, v55
    v_pk_mul_f32 v[88:89], v[72:73], v[70:71]
    v_pk_mul_f32 v[90:91], v[74:75], v[70:71]
    v_pk_mul_f32 v[92:93], v[76:77], v[70:71]
    v_pk_mul_f32 v[94:95], v[78:79], v[70:71]
    v_pk_mul_f32 v[96:97], v[80:81], v[70:71]
    v_pk_mul_f32 v[98:99], v[82:83], v[70:71]
    v_pk_mul_f32 v[100:101], v[84:85], v[70:71]
    v_pk_mul_f32 v[102:103], v[86:87], v[70:71]
    v_pk_fma_f32 v[72:73], v[88:89], v[68:69], v[72:73]
    v_pk_fma_f32 v[74:75], v[90:91], v[68:69], v[74:75]
    v_pk_fma_f32 v[76:77], v[92:93], v[68:69], v[76:77]
    v_pk_fma_f32 v[78:79], v[94:95], v[68:69], v[78:79]
    v_pk_fma_f32 v[80:81], v[96:97], v[68:69], v[80:81]
    v_pk_fma_f32 v[82:83], v[98:99], v[68:69], v[82:83]
    v_pk_fma_f32 v[84:85], v[100:101], v[68:69], v[84:85]
    v_pk_fma_f32 v[86:87], v[102:103], v[68:69], v[86:87]
    v_pk_fma_f32 v[88:89], v[72:73], v[70:71], v[88:89]
    v_pk_fma_f32 v[90:91], v[74:75], v[70:71], v[90:91]
    v_pk_fma_f32 v[92:93], v[76:77], v[70:71], v[92:93]
    v_pk_fma_f32 v[94:95], v[78:79], v[70:71], v[94:95]
    v_pk_fma_f32 v[96:97], v[80:81], v[70:71], v[96:97]
    v_pk_fma_f32 v[98:99], v[82:83], v[70:71], v[98:99]
    v_pk_fma_f32 v[100:101], v[84:85], v[70:71], v[100:101]
    v_pk_fma_f32 v[102:103], v[86:87], v[70:71], v[102:103]
    v_cvt_pk_bf16_f32 v48, v88, v89
    v_cvt_pk_bf16_f32 v49, v90, v91
    v_cvt_pk_bf16_f32 v50, v92, v93
    v_cvt_pk_bf16_f32 v51, v94, v95
    v_cvt_pk_bf16_f32 v52, v96, v97
    v_cvt_pk_bf16_f32 v53, v98, v99
    v_cvt_pk_bf16_f32 v54, v100, v101
    v_cvt_pk_bf16_f32 v55, v102, v103
    v_lshlrev_b32 v66, 5, v2
    s_mul_i32 s63, s3, 544
    s_add_u32 s63, s63, 131072
    v_add_u32 v66, s63, v66
    v_cmp_eq_u32 vcc, s97, v3
    s_mov_b64 exec, vcc
    ds_write_b128 v66, v[48:51]
    ds_write_b128 v66, v[52:55] offset:16
    s_mov_b64 exec, 1
    ds_add_u32 v44, v45 offset:12
    s_mov_b64 exec, -1
L_ln_done:
    v_mov_b32 v45, 1
    v_mov_b32 v43, 512
    s_movk_i32 s67, 1023
    s_and_b32 s13, s3, 1
    v_lshrrev_b32 v12, 2, v2
    v_and_b32 v13, 1, v3
    v_lshl_or_b32 v14, v13, 2, v12
    v_lshlrev_b32 v40, 1, v14
    v_bfe_u32 v41, v2, 1, 1
    s_lshl_b32 s63, s3, 1
    v_add_u32 v7, s63, v41
    v_xor_b32 v7, v7, v40
    v_lshlrev_b32 v7, 4, v7
    v_lshl_add_u32 v8, v3, 3, v12
    v_lshl_add_u32 v7, v8, 8, v7
    v_and_b32 v42, 1, v2
    v_lshl_add_u32 v7, v42, 3, v7
    v_add_u32 v8, 0x10000, v7
    v_and_b32 v12, 31, v1
    v_lshlrev_b32 v20, 3, v12
    v_lshlrev_b32 v13, 4, v12
    v_lshrrev_b32 v14, 5, v1
    v_lshl_add_u32 v13, v14, 10, v13
    s_lshr_b32 s10, s3, 2
    s_and_b32 s11, s3, 3
    s_lshl_b32 s11, s11, 6
    s_and_b32 s63, s61, 1
    s_lshl_b32 s63, s63, 8
    s_add_u32 s11, s11, s63
    s_lshl_b32 s63, s97, 9
    s_add_u32 s11, s11, s63
    s_and_b32 s12, s60, 1
    s_lshr_b32 s14, s61, 1
    s_lshl_b32 s63, s12, 3
    s_add_u32 s63, s63, s14
    s_lshl_b32 s63, s63, 1
    s_add_u32 s63, s63, s10
    s_lshl_b32 s24, s63, 11
    s_add_u32 s24, s24, s11
    s_add_u32 s24, s24, 4096
    s_mul_i32 s63, s12, 7
    s_add_u32 s63, s63, s14
    s_lshl_b32 s63, s63, 1
    s_add_u32 s63, s63, s10
    s_lshl_b32 s28, s63, 12
    s_xor_b32 s11, s11, 0x100
    s_add_u32 s28, s28, s11
    s_add_u32 s28, s28, 135168
    s_and_b32 s63, s61, 1
    s_lshl_b32 s63, s63, 2
    s_lshr_b32 s64, s3, 1
    s_add_u32 s63, s63, s64
    s_and_b32 s64, s60, 3
    s_lshl_b32 s64, s64, 3
    s_add_u32 s63, s63, s64
    s_lshl_b32 s63, s63, 1
    s_lshr_b32 s64, s60, 2
    s_add_u32 s63, s63, s64
    s_lshl_b32 s30, s63, 8
    s_add_u32 s30, s30, 774144
    s_lshl_b32 s64, s13, 8
    s_lshl_b32 s29, s63, 13
    s_add_u32 s29, s29, s64
    s_add_u32 s29, s29, 249856
    s_lshl_b32 s40, s63, 9
    s_add_u32 s40, s40, s64
    s_add_u32 s40, s40, 1331200
    s_mov_b32 s37, 0x3fb8aa3b
    v_lshlrev_b32 v31, 4, v2
    v_lshl_add_u32 v30, v3, 11, v31
    v_lshlrev_b32 v32, 4, v3
    s_sub_u32 s18, s3, 2
    s_lshl_b32 s39, s61, 13
    s_and_b32 s63, s18, 3
    s_lshl_b32 s63, s63, 11
    s_add_u32 s39, s39, s63
    s_add_u32 s39, s39, 135168
    s_lshl_b32 s32, s60, 5
    s_add_u32 s32, s32, s61
    s_lshl_b32 s32, s32, 10
    s_lshl_b32 s63, s3, 7
    s_add_u32 s32, s32, s63
    s_add_u32 s33, s32, 1642496
    s_add_u32 s32, s32, 1380352
    s_mov_b32 s6, 0x00030003
    s_mov_b32 s7, 0x00030003
    v_lshlrev_b32 v12, 4, v3
    v_lshl_add_u32 v5, v2, 16, v12
    v_lshl_add_u32 v6, v2, 11, v12
    v_mul_u32_u24 v9, 544, v42
    v_add_u32 v9, v9, v12
    v_add_u32 v9, 131072, v9
    v_add_u32 v10, 1088, v9
    v_lshlrev_b32 v29, 4, v2
    v_lshl_add_u32 v29, v3, 5, v29
    s_mul_i32 s63, s13, 544
    s_bfe_u32 s64, s18, 0x10001
    s_lshl_b32 s64, s64, 8
    s_add_u32 s63, s63, s64
    s_add_u32 s63, s63, 132160
    v_add_u32 v24, s63, v20
    s_waitcnt lgkmcnt(0)
    s_add_u32 s69, s62, 1
    v_mov_b32 v11, s69
    s_lshr_b32 s62, s69, 10
    v_add_u32 v25, s62, v11
    s_lshr_b32 s62, s69, 20
    v_add_u32 v27, s62, v11
    s_lshr_b32 s62, s69, 30
    v_add_u32 v28, s62, v11
    s_mov_b32 s96, -1
    s_mov_b32 s44, 1
    s_cmp_lt_u32 s3, 2
    s_cbranch_scc1 L_dryF
    s_mov_b32 s96, 0
    s_mov_b32 s44, 0
    s_mov_b64 exec, 0
L_dryF:
    s_mov_b32 s98, 0
L_lw27:
    ds_read_b32 v46, v44 offset:12
    s_add_u32 s98, s98, 1
    s_cmp_gt_u32 s98, 16777216
    s_cbranch_scc1 L_lw27_x
    s_waitcnt lgkmcnt(0)
    v_cmp_gt_u32 vcc, 2, v46
    s_cbranch_vccnz L_lw27
L_lw27_x:
    ds_read_b128 v[136:139], v9 offset:0
    ds_read_b128 v[140:143], v9 offset:64
    ds_read_b128 v[144:147], v9 offset:128
    ds_read_b128 v[148:151], v9 offset:192
    ds_read_b128 v[152:155], v9 offset:256
    ds_read_b128 v[156:159], v9 offset:320
    ds_read_b128 v[160:163], v9 offset:384
    ds_read_b128 v[164:167], v9 offset:448
    s_mov_b32 s98, 0
L_lw28:
    ds_read_b32 v46, v44 offset:0
    s_add_u32 s98, s98, 1
    s_cmp_gt_u32 s98, 16777216
    s_cbranch_scc1 L_lw28_x
    s_waitcnt lgkmcnt(0)
    v_cmp_gt_u32 vcc, 8, v46
    s_cbranch_vccnz L_lw28
L_lw28_x:
    ds_read_b64_tr_b16 v[48:49], v7 offset:0
    ds_read_b64_tr_b16 v[50:51], v7 offset:1024
    ds_read_b64_tr_b16 v[52:53], v7 offset:8192
    ds_read_b64_tr_b16 v[54:55], v7 offset:9216
    ds_read_b64_tr_b16 v[56:57], v7 offset:16384
    ds_read_b64_tr_b16 v[58:59], v7 offset:17408
    ds_read_b64_tr_b16 v[60:61], v7 offset:24576
    ds_read_b64_tr_b16 v[62:63], v7 offset:25600
    s_waitcnt lgkmcnt(0)
    v_mfma_f32_16x16x32_bf16 v[112:115], v[48:51], v[136:139], 0
    v_mfma_f32_16x16x32_bf16 v[112:115], v[52:55], v[140:143], v[112:115]
    v_mfma_f32_16x16x32_bf16 v[112:115], v[56:59], v[144:147], v[112:115]
    v_mfma_f32_16x16x32_bf16 v[112:115], v[60:63], v[148:151], v[112:115]
    s_mov_b32 s98, 0
L_lw29:
    ds_read_b32 v46, v44 offset:0
    s_add_u32 s98, s98, 1
    s_cmp_gt_u32 s98, 16777216
    s_cbranch_scc1 L_lw29_x
    s_waitcnt lgkmcnt(0)
    v_cmp_gt_u32 vcc, 16, v46
    s_cbranch_vccnz L_lw29
L_lw29_x:
    ds_read_b64_tr_b16 v[64:65], v7 offset:32768
    ds_read_b64_tr_b16 v[66:67], v7 offset:33792
    ds_read_b64_tr_b16 v[68:69], v7 offset:40960
    ds_read_b64_tr_b16 v[70:71], v7 offset:41984
    ds_read_b64_tr_b16 v[72:73], v7 offset:49152
    ds_read_b64_tr_b16 v[74:75], v7 offset:50176
    ds_read_b64_tr_b16 v[76:77], v7 offset:57344
    ds_read_b64_tr_b16 v[78:79], v7 offset:58368
    s_waitcnt lgkmcnt(0)
    v_mfma_f32_16x16x32_bf16 v[112:115], v[64:67], v[152:155], v[112:115]
    v_mfma_f32_16x16x32_bf16 v[112:115], v[68:71], v[156:159], v[112:115]
    v_mfma_f32_16x16x32_bf16 v[112:115], v[72:75], v[160:163], v[112:115]
    v_mfma_f32_16x16x32_bf16 v[112:115], v[76:79], v[164:167], v[112:115]
    s_mul_i32 exec_lo, s44, 1
    s_mov_b32 exec_hi, 0
    ds_add_u32 v44, v45 offset:8
    s_mov_b32 exec_lo, s96
    s_mov_b32 exec_hi, s96
    s_nop 4
    v_bfi_b32 v112, s67, v11, v112
    v_bfi_b32 v113, s67, v25, v113
    v_bfi_b32 v114, s67, v27, v114
    v_bfi_b32 v115, s67, v28, v115
    s_mul_i32 exec_lo, s6, s44
    s_mul_i32 exec_hi, s7, s44
    s_cbranch_execz L_dz18
    buffer_store_dwordx4 v[112:115], v5, s[48:51], s24 offen sc1
L_dz18:
    s_mov_b32 exec_lo, s96
    s_mov_b32 exec_hi, s96
    s_cmp_lt_u32 s61, 14
    s_cbranch_scc1 L_heavy
    s_mov_b32 s22, s29
    s_mov_b32 s23, s30
    s_mov_b32 s21, 0
    s_cbranch_execz L_dz19
    buffer_load_dwordx4 v[116:119], v30, s[48:51], s22 offen offset:0 sc1
    buffer_load_dwordx4 v[120:123], v30, s[48:51], s22 offen offset:512 sc1
    buffer_load_dwordx4 v[124:127], v30, s[48:51], s22 offen offset:1024 sc1
    buffer_load_dwordx4 v[128:131], v30, s[48:51], s22 offen offset:1536 sc1
    buffer_load_dwordx4 v[132:135], v31, s[48:51], s23 offen sc1
L_dz19:
    s_mov_b32 s64, 0
L_pm:
    s_waitcnt vmcnt(0)
    v_xor_b32 v14, v132, v11
    v_xor_b32 v15, v133, v25
    v_bitop3_b32 v14, v134, v27, v14 bitop3:0xbe
    v_bitop3_b32 v15, v135, v28, v15 bitop3:0xbe
    v_bitop3_b32 v12, v14, v15, s67 bitop3:0xa8
    v_cmp_ne_u32 vcc, 0, v12
    s_cbranch_vccz L_pm_ok
    s_add_u32 s64, s64, 1
    s_cmp_gt_u32 s64, 1048576
    s_cbranch_scc1 L_pm_ok
    s_mov_b64 exec, vcc
    s_add_u32 s65, s64, s21
    s_and_b32 s63, s65, 1
    s_cmp_gt_u32 s65, 256
    s_cselect_b32 s63, s63, 0
    s_mul_i32 s63, s63, 540672
    s_add_u32 s23, s30, s63
    s_cbranch_execz L_dz20
    buffer_load_dwordx4 v[132:135], v31, s[48:51], s23 offen sc1
L_dz20:
    s_mov_b32 exec_lo, s96
    s_mov_b32 exec_hi, s96
    s_branch L_pm
L_pm_ok:
    s_mov_b32 s21, s64
    s_cbranch_execz L_dz21
    buffer_load_dwordx4 v[116:119], v30, s[48:51], s22 offen offset:0 sc1
    buffer_load_dwordx4 v[120:123], v30, s[48:51], s22 offen offset:512 sc1
    buffer_load_dwordx4 v[124:127], v30, s[48:51], s22 offen offset:1024 sc1
    buffer_load_dwordx4 v[128:131], v30, s[48:51], s22 offen offset:1536 sc1
L_dz21:
    v_and_b32 v132, 0xffff0000, v132
    v_bfi_b32 v133, s67, v43, v133
    v_mov_b32 v134, v132
    s_nop 1
    v_max_f32_dpp v134, v134, v134 quad_perm:[1,0,3,2] row_mask:0xf bank_mask:0xf
    s_nop 1
    v_max_f32_dpp v134, v134, v134 quad_perm:[2,3,0,1] row_mask:0xf bank_mask:0xf
    s_nop 1
    v_max_f32_dpp v134, v134, v134 row_half_mirror row_mask:0xf bank_mask:0xf
    s_nop 1
    v_max_f32_dpp v134, v134, v134 row_mirror row_mask:0xf bank_mask:0xf
    v_sub_f32 v132, v132, v134
    v_mul_f32 v132, s37, v132
    v_exp_f32 v132, v132
    s_nop 0
    ds_bpermute_b32 v80, v32, v132 offset:0
    ds_bpermute_b32 v81, v32, v132 offset:4
    ds_bpermute_b32 v82, v32, v132 offset:8
    ds_bpermute_b32 v83, v32, v132 offset:12
    v_mul_f32 v133, v133, v132
    s_nop 1
    v_add_f32_dpp v133, v133, v133 quad_perm:[1,0,3,2] row_mask:0xf bank_mask:0xf
    s_nop 1
    v_add_f32_dpp v133, v133, v133 quad_perm:[2,3,0,1] row_mask:0xf bank_mask:0xf
    s_nop 1
    v_add_f32_dpp v133, v133, v133 row_half_mirror row_mask:0xf bank_mask:0xf
    s_nop 1
    v_add_f32_dpp v133, v133, v133 row_mirror row_mask:0xf bank_mask:0xf
    v_rcp_f32 v133, v133
    s_waitcnt lgkmcnt(0)
    s_mov_b32 s64, 0
L_po:
    s_waitcnt vmcnt(0)
    v_xor_b32 v14, v116, v11
    v_xor_b32 v15, v117, v25
    v_bitop3_b32 v14, v118, v27, v14 bitop3:0xbe
    v_bitop3_b32 v15, v119, v28, v15 bitop3:0xbe
    v_bitop3_b32 v14, v120, v11, v14 bitop3:0xbe
    v_bitop3_b32 v15, v121, v25, v15 bitop3:0xbe
    v_bitop3_b32 v14, v122, v27, v14 bitop3:0xbe
    v_bitop3_b32 v15, v123, v28, v15 bitop3:0xbe
    v_bitop3_b32 v14, v124, v11, v14 bitop3:0xbe
    v_bitop3_b32 v15, v125, v25, v15 bitop3:0xbe
    v_bitop3_b32 v14, v126, v27, v14 bitop3:0xbe
    v_bitop3_b32 v15, v127, v28, v15 bitop3:0xbe
    v_bitop3_b32 v14, v128, v11, v14 bitop3:0xbe
    v_bitop3_b32 v15, v129, v25, v15 bitop3:0xbe
    v_bitop3_b32 v14, v130, v27, v14 bitop3:0xbe
    v_bitop3_b32 v15, v131, v28, v15 bitop3:0xbe
    v_bitop3_b32 v12, v14, v15, s67 bitop3:0xa8
    v_cmp_ne_u32 vcc, 0, v12
    s_cbranch_vccz L_po_ok
    s_add_u32 s64, s64, 1
    s_cmp_gt_u32 s64, 1048576
    s_cbranch_scc1 L_po_ok
    s_mov_b64 exec, vcc
    s_add_u32 s65, s64, s21
    s_and_b32 s63, s65, 1
    s_cmp_gt_u32 s65, 256
    s_cselect_b32 s63, s63, 0
    s_mul_i32 s63, s63, 540672
    s_add_u32 s22, s29, s63
    s_cbranch_execz L_dz22
    buffer_load_dwordx4 v[116:119], v30, s[48:51], s22 offen offset:0 sc1
    buffer_load_dwordx4 v[120:123], v30, s[48:51], s22 offen offset:512 sc1
    buffer_load_dwordx4 v[124:127], v30, s[48:51], s22 offen offset:1024 sc1
    buffer_load_dwordx4 v[128:131], v30, s[48:51], s22 offen offset:1536 sc1
L_dz22:
    s_mov_b32 exec_lo, s96
    s_mov_b32 exec_hi, s96
    s_branch L_po
L_po_ok:
    v_bfi_b32 v116, s67, v43, v116
    v_bfi_b32 v117, s67, v43, v117
    v_bfi_b32 v118, s67, v43, v118
    v_bfi_b32 v119, s67, v43, v119
    v_bfi_b32 v120, s67, v43, v120
    v_bfi_b32 v121, s67, v43, v121
    v_bfi_b32 v122, s67, v43, v122
    v_bfi_b32 v123, s67, v43, v123
    v_bfi_b32 v124, s67, v43, v124
    v_bfi_b32 v125, s67, v43, v125
    v_bfi_b32 v126, s67, v43, v126
    v_bfi_b32 v127, s67, v43, v127
    v_bfi_b32 v128, s67, v43, v128
    v_bfi_b32 v129, s67, v43, v129
    v_bfi_b32 v130, s67, v43, v130
    v_bfi_b32 v131, s67, v43, v131
    v_mul_f32 v112, v116, v80
    v_mul_f32 v113, v117, v80
    v_mul_f32 v114, v118, v80
    v_mul_f32 v115, v119, v80
    v_fmac_f32 v112, v120, v81
    v_fmac_f32 v113, v121, v81
    v_fmac_f32 v114, v122, v81
    v_fmac_f32 v115, v123, v81
    v_fmac_f32 v112, v124, v82
    v_fmac_f32 v113, v125, v82
    v_fmac_f32 v114, v126, v82
    v_fmac_f32 v115, v127, v82
    v_fmac_f32 v112, v128, v83
    v_fmac_f32 v113, v129, v83
    v_fmac_f32 v114, v130, v83
    v_fmac_f32 v115, v131, v83
    v_mov_b32 v116, v112
    v_mov_b32 v117, v113
    v_mov_b32 v118, v114
    v_mov_b32 v119, v115
    s_nop 1
    v_permlane16_swap_b32 v112, v116
    v_permlane16_swap_b32 v113, v117
    v_permlane16_swap_b32 v114, v118
    v_permlane16_swap_b32 v115, v119
    s_nop 1
    v_pk_add_f32 v[112:113], v[112:113], v[116:117]
    v_pk_add_f32 v[114:115], v[114:115], v[118:119]
    v_mov_b32 v116, v112
    v_mov_b32 v117, v113
    v_mov_b32 v118, v114
    v_mov_b32 v119, v115
    s_nop 1
    v_permlane32_swap_b32 v112, v116
    v_permlane32_swap_b32 v113, v117
    v_permlane32_swap_b32 v114, v118
    v_permlane32_swap_b32 v115, v119
    s_nop 1
    v_pk_add_f32 v[112:113], v[112:113], v[116:117]
    v_pk_add_f32 v[114:115], v[114:115], v[118:119]
    v_mul_f32 v112, v112, v133
    v_mul_f32 v113, v113, v133
    v_mul_f32 v114, v114, v133
    v_mul_f32 v115, v115, v133
    v_cvt_pk_bf16_f32 v116, v112, v113
    v_cvt_pk_bf16_f32 v117, v114, v115
    v_lshlrev_b32 v112, 16, v116
    v_and_b32 v113, 0xffff0000, v116
    v_lshlrev_b32 v114, 16, v117
    v_and_b32 v115, 0xffff0000, v117
    v_bfi_b32 v112, s67, v11, v112
    v_bfi_b32 v113, s67, v25, v113
    v_bfi_b32 v114, s67, v27, v114
    v_bfi_b32 v115, s67, v28, v115
    s_mul_i32 exec_lo, s44, 0xffff
    s_mov_b32 exec_hi, 0
    s_cbranch_execz L_dz23
    buffer_store_dwordx4 v[112:115], v31, s[48:51], s40 offen sc1
L_dz23:
    s_mov_b32 exec_lo, s96
    s_mov_b32 exec_hi, s96
    s_branch L_dryendF
L_heavy:
    s_mov_b32 s98, 0
L_lw30:
    ds_read_b32 v46, v44 offset:0
    s_add_u32 s98, s98, 1
    s_cmp_gt_u32 s98, 16777216
    s_cbranch_scc1 L_lw30_x
    s_waitcnt lgkmcnt(0)
    v_cmp_gt_u32 vcc, 24, v46
    s_cbranch_vccnz L_lw30
L_lw30_x:
    ds_read_b64_tr_b16 v[48:49], v8 offset:0
    ds_read_b64_tr_b16 v[50:51], v8 offset:1024
    ds_read_b64_tr_b16 v[52:53], v8 offset:8192
    ds_read_b64_tr_b16 v[54:55], v8 offset:9216
    ds_read_b64_tr_b16 v[56:57], v8 offset:16384
    ds_read_b64_tr_b16 v[58:59], v8 offset:17408
    ds_read_b64_tr_b16 v[60:61], v8 offset:24576
    ds_read_b64_tr_b16 v[62:63], v8 offset:25600
    s_waitcnt lgkmcnt(0)
    v_mfma_f32_16x16x32_bf16 v[112:115], v[48:51], v[136:139], 0
    v_mfma_f32_16x16x32_bf16 v[112:115], v[52:55], v[140:143], v[112:115]
    v_mfma_f32_16x16x32_bf16 v[112:115], v[56:59], v[144:147], v[112:115]
    v_mfma_f32_16x16x32_bf16 v[112:115], v[60:63], v[148:151], v[112:115]
    s_mov_b32 s98, 0
L_lw31:
    ds_read_b32 v46, v44 offset:0
    s_add_u32 s98, s98, 1
    s_cmp_gt_u32 s98, 16777216
    s_cbranch_scc1 L_lw31_x
    s_waitcnt lgkmcnt(0)
    v_cmp_gt_u32 vcc, 32, v46
    s_cbranch_vccnz L_lw31
L_lw31_x:
    ds_read_b64_tr_b16 v[64:65], v8 offset:32768
    ds_read_b64_tr_b16 v[66:67], v8 offset:33792
    ds_read_b64_tr_b16 v[68:69], v8 offset:40960
    ds_read_b64_tr_b16 v[70:71], v8 offset:41984
    ds_read_b64_tr_b16 v[72:73], v8 offset:49152
    ds_read_b64_tr_b16 v[74:75], v8 offset:50176
    ds_read_b64_tr_b16 v[76:77], v8 offset:57344
    ds_read_b64_tr_b16 v[78:79], v8 offset:58368
    s_waitcnt lgkmcnt(0)
    v_mfma_f32_16x16x32_bf16 v[112:115], v[64:67], v[152:155], v[112:115]
    v_mfma_f32_16x16x32_bf16 v[112:115], v[68:71], v[156:159], v[112:115]
    v_mfma_f32_16x16x32_bf16 v[112:115], v[72:75], v[160:163], v[112:115]
    v_mfma_f32_16x16x32_bf16 v[112:115], v[76:79], v[164:167], v[112:115]
    s_nop 7
    v_bfi_b32 v112, s67, v11, v112
    v_bfi_b32 v113, s67, v25, v113
    v_bfi_b32 v114, s67, v27, v114
    v_bfi_b32 v115, s67, v28, v115
    s_mul_i32 exec_lo, s6, s44
    s_mul_i32 exec_hi, s7, s44
    s_cbranch_execz L_dz24
    buffer_store_dwordx4 v[112:115], v6, s[48:51], s28 offen sc1
L_dz24:
    s_mov_b32 exec_lo, s96
    s_mov_b32 exec_hi, s96
    s_cmp_ge_u32 s18, 4
    s_cbranch_scc1 L_no_hg
    s_mov_b32 s98, 0
L_lw32:
    ds_read_b32 v46, v44 offset:0
    s_add_u32 s98, s98, 1
    s_cmp_gt_u32 s98, 16777216
    s_cbranch_scc1 L_lw32_x
    s_waitcnt lgkmcnt(0)
    v_cmp_gt_u32 vcc, 46, v46
    s_cbranch_vccnz L_lw32
L_lw32_x:
    s_cbranch_execz L_dz25
    buffer_load_dwordx4 v[116:119], v13, s[48:51], s39 offen offset:0 sc1
    buffer_load_dwordx4 v[120:123], v13, s[48:51], s39 offen offset:512 sc1
L_dz25:
L_no_hg:
    s_mov_b32 s98, 0
L_lw33:
    ds_read_b32 v46, v44 offset:0
    s_add_u32 s98, s98, 1
    s_cmp_gt_u32 s98, 16777216
    s_cbranch_scc1 L_lw33_x
    s_waitcnt lgkmcnt(0)
    v_cmp_gt_u32 vcc, 48, v46
    s_cbranch_vccnz L_lw33
L_lw33_x:
    ds_read_b64_tr_b16 v[48:49], v7 offset:0
    ds_read_b64_tr_b16 v[50:51], v7 offset:1024
    ds_read_b64_tr_b16 v[52:53], v7 offset:8192
    ds_read_b64_tr_b16 v[54:55], v7 offset:9216
    ds_read_b64_tr_b16 v[56:57], v7 offset:16384
    ds_read_b64_tr_b16 v[58:59], v7 offset:17408
    ds_read_b64_tr_b16 v[60:61], v7 offset:24576
    ds_read_b64_tr_b16 v[62:63], v7 offset:25600
    ds_read_b64_tr_b16 v[64:65], v7 offset:32768
    ds_read_b64_tr_b16 v[66:67], v7 offset:33792
    ds_read_b64_tr_b16 v[68:69], v7 offset:40960
    ds_read_b64_tr_b16 v[70:71], v7 offset:41984
    ds_read_b64_tr_b16 v[72:73], v7 offset:49152
    ds_read_b64_tr_b16 v[74:75], v7 offset:50176
    ds_read_b64_tr_b16 v[76:77], v7 offset:57344
    ds_read_b64_tr_b16 v[78:79], v7 offset:58368
    s_cmp_ge_u32 s18, 4
    s_cbranch_scc1 L_h_done
    s_mov_b32 s64, 0
L_ph:
    s_waitcnt vmcnt(0)
    v_xor_b32 v14, v116, v11
    v_xor_b32 v15, v117, v25
    v_bitop3_b32 v14, v118, v27, v14 bitop3:0xbe
    v_bitop3_b32 v15, v119, v28, v15 bitop3:0xbe
    v_bitop3_b32 v14, v120, v11, v14 bitop3:0xbe
    v_bitop3_b32 v15, v121, v25, v15 bitop3:0xbe
    v_bitop3_b32 v14, v122, v27, v14 bitop3:0xbe
    v_bitop3_b32 v15, v123, v28, v15 bitop3:0xbe
    v_bitop3_b32 v12, v14, v15, s67 bitop3:0xa8
    v_cmp_ne_u32 vcc, 0, v12
    s_cbranch_vccz L_ph_ok
    s_add_u32 s64, s64, 1
    s_cmp_gt_u32 s64, 1048576
    s_cbranch_scc1 L_ph_ok
    s_mov_b64 exec, vcc
    s_cbranch_execz L_dz26
    buffer_load_dwordx4 v[116:119], v13, s[48:51], s39 offen offset:0 sc1
    buffer_load_dwordx4 v[120:123], v13, s[48:51], s39 offen offset:512 sc1
L_dz26:
    s_mov_b32 exec_lo, s96
    s_mov_b32 exec_hi, s96
    s_branch L_ph
L_ph_ok:
    v_bfi_b32 v116, s67, v43, v116
    v_bfi_b32 v117, s67, v43, v117
    v_bfi_b32 v118, s67, v43, v118
    v_bfi_b32 v119, s67, v43, v119
    v_bfi_b32 v120, s67, v43, v120
    v_bfi_b32 v121, s67, v43, v121
    v_bfi_b32 v122, s67, v43, v122
    v_bfi_b32 v123, s67, v43, v123
    v_pk_add_f32 v[116:117], v[116:117], v[120:121]
    v_pk_add_f32 v[118:119], v[118:119], v[122:123]
    v_mov_b32 v120, v116
    v_mov_b32 v121, v117
    v_mov_b32 v122, v118
    v_mov_b32 v123, v119
    s_nop 1
    v_permlane32_swap_b32 v116, v120
    v_permlane32_swap_b32 v117, v121
    v_permlane32_swap_b32 v118, v122
    v_permlane32_swap_b32 v119, v123
    s_nop 1
    v_pk_add_f32 v[116:117], v[116:117], v[120:121]
    v_pk_add_f32 v[118:119], v[118:119], v[122:123]
    v_max_f32 v116, 0, v116
    v_max_f32 v117, 0, v117
    v_max_f32 v118, 0, v118
    v_max_f32 v119, 0, v119
    v_cvt_pk_bf16_f32 v120, v116, v117
    v_cvt_pk_bf16_f32 v121, v118, v119
    ds_write_b64 v24, v[120:121]
L_h_done:
    s_waitcnt lgkmcnt(0)
    s_cbranch_execz L_dz27
    s_barrier
L_dz27:
    ds_read_b128 v[80:83], v10 offset:0
    ds_read_b128 v[84:87], v10 offset:64
    ds_read_b128 v[88:91], v10 offset:128
    ds_read_b128 v[92:95], v10 offset:192
    ds_read_b128 v[96:99], v10 offset:256
    ds_read_b128 v[100:103], v10 offset:320
    ds_read_b128 v[104:107], v10 offset:384
    ds_read_b128 v[108:111], v10 offset:448
    s_waitcnt lgkmcnt(7)
    v_mfma_f32_16x16x32_bf16 v[112:115], v[48:51], v[80:83], 0
    s_waitcnt lgkmcnt(6)
    v_mfma_f32_16x16x32_bf16 v[112:115], v[52:55], v[84:87], v[112:115]
    s_waitcnt lgkmcnt(5)
    v_mfma_f32_16x16x32_bf16 v[112:115], v[56:59], v[88:91], v[112:115]
    s_waitcnt lgkmcnt(4)
    v_mfma_f32_16x16x32_bf16 v[112:115], v[60:63], v[92:95], v[112:115]
    s_waitcnt lgkmcnt(3)
    v_mfma_f32_16x16x32_bf16 v[112:115], v[64:67], v[96:99], v[112:115]
    s_waitcnt lgkmcnt(2)
    v_mfma_f32_16x16x32_bf16 v[112:115], v[68:71], v[100:103], v[112:115]
    s_waitcnt lgkmcnt(1)
    v_mfma_f32_16x16x32_bf16 v[112:115], v[72:75], v[104:107], v[112:115]
    s_waitcnt lgkmcnt(0)
    v_mfma_f32_16x16x32_bf16 v[112:115], v[76:79], v[108:111], v[112:115]
    s_nop 7
    v_bfi_b32 v112, s67, v11, v112
    v_bfi_b32 v113, s67, v25, v113
    v_bfi_b32 v114, s67, v27, v114
    v_bfi_b32 v115, s67, v28, v115
    s_mul_i32 exec_lo, s6, s44
    s_mul_i32 exec_hi, s7, s44
    s_cbranch_execz L_dz28
    buffer_store_dwordx4 v[112:115], v29, s[48:51], s32 offen
    buffer_store_dwordx4 v[112:115], v29, s[48:51], s33 offen sc1
L_dz28:
    s_mov_b32 exec_lo, s96
    s_mov_b32 exec_hi, s96
L_dryendF:
    s_cmp_lg_u32 s96, 0
    s_cbranch_scc1 L_fin
    s_mov_b32 s96, -1
    s_mov_b32 s44, 1
    s_mov_b64 exec, -1
    s_branch L_dryF
L_fin:
L_end:
    s_endpgm
.section .rodata,"a"
.p2align 6
.amdhsa_kernel recurrent_scan__sliding_block_cached__dense_activation_relu__decode_kernel
  .amdhsa_next_free_vgpr 168
  .amdhsa_next_free_sgpr 100
  .amdhsa_accum_offset 168
  .amdhsa_group_segment_fixed_size 0
  .amdhsa_kernarg_size 88
  .amdhsa_user_sgpr_count 2
  .amdhsa_user_sgpr_kernarg_segment_ptr 1
  .amdhsa_system_sgpr_workgroup_id_x 1
.end_amdhsa_kernel
```
